```python
import torch

def _softmax(x, axis=-1):
    return torch.softmax(x, dim=axis)
def _gelu(x):
    return torch.nn.functional.gelu(x, approximate="tanh")
def _silu(x):
    return torch.nn.functional.silu(x)
def _sigmoid(x):
    return torch.sigmoid(x)
def _layernorm(x, axis=-1, eps=1e-5):
    m = x.mean(dim=axis, keepdim=True)
    v = x.var(dim=axis, keepdim=True, unbiased=False)
    return (x - m) / torch.sqrt(v + eps)
def _scatter_add(tgt, idx, src, axis=0):
    return tgt.clone().index_add_(axis, idx, src)
def _segment_sum(src, seg, n):
    out = torch.zeros((n,) + src.shape[1:], dtype=src.dtype)
    return out.index_add_(0, seg, src)
def _pad(x, pw):
    flat = tuple(v for pair in reversed(pw) for v in pair)
    return torch.nn.functional.pad(x, flat)

kernel_name = 'parallel_sum__grouped_kv_mqa__glu_gated_swiglu__prompt'

def setup_inputs():

    _w = (lambda a: (lambda t: t.to(torch.bfloat16) if t.is_floating_point() else t)(torch.as_tensor(a)))
    def _A_setup():
        B, S, D, H = 1, 2048, 512, 32
        Dh = D // H
        return {
            "x": _w((lambda *s: torch.randn(*s, dtype=torch.bfloat16) * 0.05)(B, S, D)),
            "wq": _w((lambda *s: torch.randn(*s, dtype=torch.bfloat16) * 0.05)(D, H * Dh)),
            "wk": _w((lambda *s: torch.randn(*s, dtype=torch.bfloat16) * 0.05)(D, Dh)),
            "wv": _w((lambda *s: torch.randn(*s, dtype=torch.bfloat16) * 0.05)(D, Dh)),
            "wo": _w((lambda *s: torch.randn(*s, dtype=torch.bfloat16) * 0.05)(H * Dh, D)),
        }
    _A_in = _A_setup()

    def _B_setup():
        B, S, D, F = 1, 2048, 512, 1792
        return {
            "x": _w((lambda *s: torch.randn(*s, dtype=torch.bfloat16) * 0.05)(B, S, D)),
            "w1": _w((lambda *s: torch.randn(*s, dtype=torch.bfloat16) * 0.4)(D, F) * (2.0 / D) ** 0.5),
            "w3": _w((lambda *s: torch.randn(*s, dtype=torch.bfloat16) * 0.4)(D, F) * (2.0 / D) ** 0.5),
            "w2": _w((lambda *s: torch.randn(*s, dtype=torch.bfloat16) * 0.4)(F, D) * (2.0 / F) ** 0.5),
        }
    _B_in = _B_setup()

    return {
        "A_x": _A_in["x"],
        "A_wq": _A_in["wq"],
        "A_wk": _A_in["wk"],
        "A_wv": _A_in["wv"],
        "A_wo": _A_in["wo"],
        "B_x": _B_in["x"],
        "B_w1": _B_in["w1"],
        "B_w3": _B_in["w3"],
        "B_w2": _B_in["w2"],
    }

def reference(A_x, A_wq, A_wk, A_wv, A_wo, B_x, B_w1, B_w3, B_w2):
    def _A_ref(x, wq, wk, wv, wo):
        B, S, D = x.shape
        H = 32
        Dh = D // H
        q = (lambda x, *d: x.permute(*d))((x @ wq).reshape(B, S, H, Dh), 0, 2, 1, 3)
        k = x @ wk
        v = x @ wv
        scores = torch.einsum("bhqd,bkd->bhqk", q, k) * (Dh ** -0.5)
        p = _softmax(scores, axis=-1)
        o = torch.einsum("bhqk,bkd->bhqd", p, v)
        return (lambda x, *d: x.permute(*d))(o, 0, 2, 1, 3).reshape(B, S, H * Dh) @ wo

    def _B_ref(x, w1, w3, w2):
        gate = torch.einsum("bsd,df->bsf", x, w1)
        up = torch.einsum("bsd,df->bsf", x, w3)
        h = _silu(gate) * up
        out = torch.einsum("bsf,fd->bsd", h, w2)
        return out

    x = A_x
    xn = _layernorm(x, axis=-1)
    return x + _A_ref(xn, A_wq, A_wk, A_wv, A_wo) + _B_ref(xn, B_w1, B_w3, B_w2)
```

```asm
; @launch grid=(256,1,1) block=(512,1,1) lds=163840
.amdgcn_target "amdgcn-amd-amdhsa--gfx950"
.text
.globl parallel_sum__grouped_kv_mqa__glu_gated_swiglu__prompt_kernel
.p2align 8
.type parallel_sum__grouped_kv_mqa__glu_gated_swiglu__prompt_kernel,@function
parallel_sum__grouped_kv_mqa__glu_gated_swiglu__prompt_kernel:
    s_cmp_ge_u32 s2, 256
    s_cbranch_scc1 L_end
    s_load_dwordx2 s[4:5], s[0:1], 0
    s_load_dwordx2 s[16:17], s[0:1], 16
    s_load_dwordx2 s[20:21], s[0:1], 24
    s_load_dwordx2 s[8:9], s[0:1], 88
    s_load_dwordx2 s[12:13], s[0:1], 8
    s_load_dwordx2 s[24:25], s[0:1], 48
    s_load_dwordx2 s[28:29], s[0:1], 56
    s_load_dwordx2 s[32:33], s[0:1], 64
    s_load_dwordx2 s[36:37], s[0:1], 32
    s_load_dwordx2 s[40:41], s[0:1], 72
    s_getpc_b64 s[80:81]
L_pc:
    v_lshrrev_b32 v3, 6, v0
    v_and_b32 v1, 63, v0
    v_readfirstlane_b32 s44, v3
    v_lshlrev_b32 v2, 4, v1
    s_and_b32 s57, s2, 7
    s_lshr_b32 s58, s2, 3
    s_mov_b32 s47, s2
    s_and_b32 s46, s2, 15
    s_mov_b32 s6, 2097152
    s_mov_b32 s7, 0x20000
    s_mov_b32 s18, 16384
    s_mov_b32 s19, 0x20000
    s_mov_b32 s22, 16384
    s_mov_b32 s23, 0x20000
    s_mov_b32 s10, 16777216
    s_mov_b32 s11, 0x20000
    s_mov_b32 s14, 524288
    s_mov_b32 s15, 0x20000
    s_mov_b32 s26, 1835008
    s_mov_b32 s27, 0x20000
    s_mov_b32 s30, 1835008
    s_mov_b32 s31, 0x20000
    s_mov_b32 s34, 1835008
    s_mov_b32 s35, 0x20000
    s_mov_b32 s38, 524288
    s_mov_b32 s39, 0x20000
    s_mov_b32 s42, 2097152
    s_mov_b32 s43, 0x20000
    s_lshl3_add_u32 s50, s47, s44
    s_lshl_b32 s50, s50, 10
    s_mov_b32 s49, 0xffff0000
    s_waitcnt lgkmcnt(0)
    buffer_load_dwordx4 v[64:67], v2, s[4:7], s50 offen
    s_load_dword s48, s[8:9], 0
    v_mov_b32 v3, 0
    v_mov_b32 v4, 0
    v_mov_b32 v5, 0
    v_mov_b32 v6, 0
    v_mov_b32 v7, 0
    v_mov_b32 v8, 0
    v_mov_b32 v9, 0
    v_mov_b32 v17, 0
    s_cmp_lt_u32 s44, 4
    s_cbranch_scc1 L_g_early
    s_sub_u32 s79, s44, 4
    s_lshl_b32 s50, s79, 12
    s_add_u32 m0, s50, 98304
    s_nop 0
    buffer_load_dwordx4 v2, s[16:19], s50 offen offset:0 lds
    buffer_load_dwordx4 v2, s[16:19], s50 offen offset:1024 lds
    buffer_load_dwordx4 v2, s[16:19], s50 offen offset:2048 lds
    buffer_load_dwordx4 v2, s[16:19], s50 offen offset:3072 lds
    s_add_u32 m0, s50, 114688
    s_nop 0
    buffer_load_dwordx4 v2, s[20:23], s50 offen offset:0 lds
    buffer_load_dwordx4 v2, s[20:23], s50 offen offset:1024 lds
    buffer_load_dwordx4 v2, s[20:23], s50 offen offset:2048 lds
    buffer_load_dwordx4 v2, s[20:23], s50 offen offset:3072 lds
    v_add_u32 v11, -4, v1
    v_cmp_gt_u32 vcc, 8, v11
    v_lshlrev_b32 v10, 2, v1
    v_add_u32 v10, 148480, v10
    v_cndmask_b32 v11, 0, -1, vcc
    ds_write_b32 v10, v11
    v_and_b32 v3, 7, v1
    v_lshrrev_b32 v10, 4, v1
    v_mul_u32_u24 v11, 1040, v3
    v_lshl_add_u32 v12, v10, 4, v11
    v_and_b32 v13, 15, v1
    v_lshlrev_b32 v4, 3, v13
    v_lshl_add_u32 v4, v10, 8, v4
    s_lshl_b32 s50, s79, 14
    s_add_u32 s50, s50, 98304
    v_add_u32 v4, s50, v4
    v_lshlrev_b32 v13, 4, v13
    v_lshl_add_u32 v6, v10, 3, v13
    v_bfe_u32 v14, v1, 4, 1
    v_lshl_add_u32 v5, v14, 9, v13
    v_lshrrev_b32 v14, 5, v1
    v_lshl_add_u32 v5, v14, 3, v5
    v_mov_b32 v7, 148560
    v_lshrrev_b32 v10, 3, v1
    v_lshl_add_u32 v8, v10, 4, v11
    s_and_b32 s51, s79, 1
    s_lshl_b32 s51, s51, 9
    s_add_u32 s51, s51, 131072
    v_add_u32 v8, s51, v8
    v_lshlrev_b32 v9, 4, v3
    v_and_b32 v14, 1, v10
    v_lshl_add_u32 v9, v14, 9, v9
    v_lshrrev_b32 v10, 1, v10
    v_lshl_add_u32 v9, v10, 10, v9
    v_add_u32 v3, 131072, v12
    s_waitcnt vmcnt(8)
L_ln:
    v_lshlrev_b32 v68, 16, v64
    v_and_b32 v69, s49, v64
    v_lshlrev_b32 v70, 16, v65
    v_and_b32 v71, s49, v65
    v_lshlrev_b32 v72, 16, v66
    v_and_b32 v73, s49, v66
    v_lshlrev_b32 v74, 16, v67
    v_and_b32 v75, s49, v67
    s_mul_i32 s50, s44, 1040
    s_add_u32 s50, s50, 131072
    v_add_f32 v84, v68, v69
    v_add_f32 v85, v70, v71
    v_add_f32 v86, v72, v73
    v_add_f32 v87, v74, v75
    v_add_f32 v84, v84, v85
    v_add_f32 v86, v86, v87
    v_add_f32 v84, v84, v86
    s_nop 1
    v_add_f32_dpp v84, v84, v84 quad_perm:[1,0,3,2] row_mask:0xf bank_mask:0xf
    s_nop 1
    v_add_f32_dpp v84, v84, v84 quad_perm:[2,3,0,1] row_mask:0xf bank_mask:0xf
    s_nop 1
    v_add_f32_dpp v84, v84, v84 row_half_mirror row_mask:0xf bank_mask:0xf
    s_nop 1
    v_add_f32_dpp v84, v84, v84 row_mirror row_mask:0xf bank_mask:0xf
    v_mov_b32 v85, v84
    s_nop 1
    v_permlane16_swap_b32 v84, v85
    v_add_f32 v84, v84, v85
    v_mov_b32 v85, v84
    s_nop 1
    v_permlane32_swap_b32 v84, v85
    v_add_f32 v84, v84, v85
    v_mul_f32 v84, 0x3b000000, v84
    v_sub_f32 v76, v68, v84
    v_sub_f32 v77, v69, v84
    v_sub_f32 v78, v70, v84
    v_sub_f32 v79, v71, v84
    v_sub_f32 v80, v72, v84
    v_sub_f32 v81, v73, v84
    v_sub_f32 v82, v74, v84
    v_sub_f32 v83, v75, v84
    v_mul_f32 v85, v76, v76
    v_mul_f32 v86, v77, v77
    v_fmac_f32 v85, v78, v78
    v_fmac_f32 v86, v79, v79
    v_fmac_f32 v85, v80, v80
    v_fmac_f32 v86, v81, v81
    v_fmac_f32 v85, v82, v82
    v_fmac_f32 v86, v83, v83
    v_add_f32 v85, v85, v86
    s_nop 1
    v_add_f32_dpp v85, v85, v85 quad_perm:[1,0,3,2] row_mask:0xf bank_mask:0xf
    s_nop 1
    v_add_f32_dpp v85, v85, v85 quad_perm:[2,3,0,1] row_mask:0xf bank_mask:0xf
    s_nop 1
    v_add_f32_dpp v85, v85, v85 row_half_mirror row_mask:0xf bank_mask:0xf
    s_nop 1
    v_add_f32_dpp v85, v85, v85 row_mirror row_mask:0xf bank_mask:0xf
    v_mov_b32 v86, v85
    s_nop 1
    v_permlane16_swap_b32 v85, v86
    v_add_f32 v85, v85, v86
    v_mov_b32 v86, v85
    s_nop 1
    v_permlane32_swap_b32 v85, v86
    v_add_f32 v85, v85, v86
    v_mul_f32 v85, 0x3b000000, v85
    v_cvt_pk_bf16_f32 v86, v84, v85
    v_and_b32 v87, s49, v86
    v_lshlrev_b32 v86, 16, v86
    v_add_f32 v87, 0x3727c5ac, v87
    v_sub_f32 v68, v68, v86
    v_sub_f32 v69, v69, v86
    v_cvt_pk_bf16_f32 v87, v87, v87
    v_sub_f32 v70, v70, v86
    v_lshlrev_b32 v87, 16, v87
    v_sub_f32 v71, v71, v86
    v_sqrt_f32 v87, v87
    v_sub_f32 v72, v72, v86
    v_sub_f32 v73, v73, v86
    v_sub_f32 v74, v74, v86
    v_sub_f32 v75, v75, v86
    v_cvt_pk_bf16_f32 v87, v87, v87
    v_cvt_pk_bf16_f32 v64, v68, v69
    v_cvt_pk_bf16_f32 v65, v70, v71
    v_lshlrev_b32 v87, 16, v87
    v_cvt_pk_bf16_f32 v66, v72, v73
    v_rcp_f32 v87, v87
    v_cvt_pk_bf16_f32 v67, v74, v75
    v_lshlrev_b32 v68, 16, v64
    v_and_b32 v69, s49, v64
    v_lshlrev_b32 v70, 16, v65
    v_and_b32 v71, s49, v65
    v_lshlrev_b32 v72, 16, v66
    v_and_b32 v73, s49, v66
    v_lshlrev_b32 v74, 16, v67
    v_and_b32 v75, s49, v67
    v_mul_f32 v68, v68, v87
    v_mul_f32 v69, v69, v87
    v_mul_f32 v70, v70, v87
    v_mul_f32 v71, v71, v87
    v_mul_f32 v72, v72, v87
    v_mul_f32 v73, v73, v87
    v_mul_f32 v74, v74, v87
    v_mul_f32 v75, v75, v87
    v_add_u32 v88, s50, v2
    v_cvt_pk_bf16_f32 v64, v68, v69
    v_cvt_pk_bf16_f32 v65, v70, v71
    v_cvt_pk_bf16_f32 v66, v72, v73
    v_cvt_pk_bf16_f32 v67, v74, v75
    ds_write_b128 v88, v[64:67]
    s_waitcnt lgkmcnt(0)
    s_mul_i32 s48, s48, 0x9E3779B1
    s_add_u32 s48, s48, 0x7F4A7C15
    s_cmp_lt_u32 s44, 4
    s_cbranch_scc1 L_g_bar1
    s_waitcnt vmcnt(0)
    s_barrier
    s_cmp_ge_u32 s44, 6
    s_cbranch_scc1 L_xn_store
    ds_read_b128 v[64:67], v3 offset:0
    ds_read_b64_tr_b16 v[68:69], v4 offset:0
    ds_read_b64_tr_b16 v[70:71], v4 offset:128
    ds_read_b128 v[72:75], v3 offset:64
    ds_read_b64_tr_b16 v[76:77], v4 offset:1024
    ds_read_b64_tr_b16 v[78:79], v4 offset:1152
    ds_read_b128 v[80:83], v3 offset:128
    ds_read_b64_tr_b16 v[84:85], v4 offset:2048
    ds_read_b64_tr_b16 v[86:87], v4 offset:2176
    ds_read_b128 v[88:91], v3 offset:192
    ds_read_b64_tr_b16 v[92:93], v4 offset:3072
    ds_read_b64_tr_b16 v[94:95], v4 offset:3200
    ds_read_b128 v[96:99], v3 offset:256
    ds_read_b64_tr_b16 v[100:101], v4 offset:4096
    ds_read_b64_tr_b16 v[102:103], v4 offset:4224
    s_cmp_eq_u32 s44, 5
    s_cbranch_scc1 L_vproj
    s_waitcnt lgkmcnt(12)
    v_mfma_f32_16x16x32_bf16 v[112:115], v[68:71], v[64:67], 0
    ds_read_b128 v[64:67], v3 offset:320
    ds_read_b64_tr_b16 v[68:69], v4 offset:5120
    ds_read_b64_tr_b16 v[70:71], v4 offset:5248
    s_waitcnt lgkmcnt(12)
    v_mfma_f32_16x16x32_bf16 v[112:115], v[76:79], v[72:75], v[112:115]
    ds_read_b128 v[72:75], v3 offset:384
    ds_read_b64_tr_b16 v[76:77], v4 offset:6144
    ds_read_b64_tr_b16 v[78:79], v4 offset:6272
    s_waitcnt lgkmcnt(12)
    v_mfma_f32_16x16x32_bf16 v[112:115], v[84:87], v[80:83], v[112:115]
    ds_read_b128 v[80:83], v3 offset:448
    ds_read_b64_tr_b16 v[84:85], v4 offset:7168
    ds_read_b64_tr_b16 v[86:87], v4 offset:7296
    s_waitcnt lgkmcnt(12)
    v_mfma_f32_16x16x32_bf16 v[112:115], v[92:95], v[88:91], v[112:115]
    ds_read_b128 v[88:91], v3 offset:512
    ds_read_b64_tr_b16 v[92:93], v4 offset:8192
    ds_read_b64_tr_b16 v[94:95], v4 offset:8320
    s_waitcnt lgkmcnt(12)
    v_mfma_f32_16x16x32_bf16 v[112:115], v[100:103], v[96:99], v[112:115]
    ds_read_b128 v[96:99], v3 offset:576
    ds_read_b64_tr_b16 v[100:101], v4 offset:9216
    ds_read_b64_tr_b16 v[102:103], v4 offset:9344
    s_waitcnt lgkmcnt(12)
    v_mfma_f32_16x16x32_bf16 v[112:115], v[68:71], v[64:67], v[112:115]
    ds_read_b128 v[64:67], v3 offset:640
    ds_read_b64_tr_b16 v[68:69], v4 offset:10240
    ds_read_b64_tr_b16 v[70:71], v4 offset:10368
    s_waitcnt lgkmcnt(12)
    v_mfma_f32_16x16x32_bf16 v[112:115], v[76:79], v[72:75], v[112:115]
    ds_read_b128 v[72:75], v3 offset:704
    ds_read_b64_tr_b16 v[76:77], v4 offset:11264
    ds_read_b64_tr_b16 v[78:79], v4 offset:11392
    s_waitcnt lgkmcnt(12)
    v_mfma_f32_16x16x32_bf16 v[112:115], v[84:87], v[80:83], v[112:115]
    ds_read_b128 v[80:83], v3 offset:768
    ds_read_b64_tr_b16 v[84:85], v4 offset:12288
    ds_read_b64_tr_b16 v[86:87], v4 offset:12416
    s_waitcnt lgkmcnt(12)
    v_mfma_f32_16x16x32_bf16 v[112:115], v[92:95], v[88:91], v[112:115]
    ds_read_b128 v[88:91], v3 offset:832
    ds_read_b64_tr_b16 v[92:93], v4 offset:13312
    ds_read_b64_tr_b16 v[94:95], v4 offset:13440
    s_waitcnt lgkmcnt(12)
    v_mfma_f32_16x16x32_bf16 v[112:115], v[100:103], v[96:99], v[112:115]
    ds_read_b128 v[96:99], v3 offset:896
    ds_read_b64_tr_b16 v[100:101], v4 offset:14336
    ds_read_b64_tr_b16 v[102:103], v4 offset:14464
    s_waitcnt lgkmcnt(12)
    v_mfma_f32_16x16x32_bf16 v[112:115], v[68:71], v[64:67], v[112:115]
    ds_read_b128 v[64:67], v3 offset:960
    ds_read_b64_tr_b16 v[68:69], v4 offset:15360
    ds_read_b64_tr_b16 v[70:71], v4 offset:15488
    s_waitcnt lgkmcnt(12)
    v_mfma_f32_16x16x32_bf16 v[112:115], v[76:79], v[72:75], v[112:115]
    s_waitcnt lgkmcnt(9)
    v_mfma_f32_16x16x32_bf16 v[112:115], v[84:87], v[80:83], v[112:115]
    s_waitcnt lgkmcnt(6)
    v_mfma_f32_16x16x32_bf16 v[112:115], v[92:95], v[88:91], v[112:115]
    s_waitcnt lgkmcnt(3)
    v_mfma_f32_16x16x32_bf16 v[112:115], v[100:103], v[96:99], v[112:115]
    s_waitcnt lgkmcnt(0)
    v_mfma_f32_16x16x32_bf16 v[112:115], v[68:71], v[64:67], v[112:115]
    s_lshr_b32 s50, s47, 2
    s_lshl_b32 s50, s50, 10
    s_and_b32 s51, s46, 3
    s_lshl_b32 s51, s51, 7
    s_add_u32 s50, s50, s51
    s_add_u32 s50, s50, 3145728
    s_mov_b32 s52, 0x00ff00ff
    s_mov_b32 s53, 0x00ff00ff
    s_nop 0
    v_cvt_pk_bf16_f32 v8, v112, v113
    v_cvt_pk_bf16_f32 v9, v114, v115
    s_mov_b64 exec, s[52:53]
    buffer_store_dwordx2 v[8:9], v5, s[8:11], s50 offen sc1
    s_mov_b64 exec, -1
    v_mul_f32 v11, v112, v112
    v_fmac_f32 v11, v113, v113
    v_fmac_f32 v11, v114, v114
    v_fmac_f32 v11, v115, v115
    v_mov_b32 v12, v11
    s_nop 1
    v_permlane16_swap_b32 v11, v12
    v_add_f32 v11, v11, v12
    v_mov_b32 v12, v11
    s_nop 1
    v_permlane32_swap_b32 v11, v12
    v_add_f32 v11, v11, v12
    v_and_b32 v11, 0x7fffffff, v11
    s_nop 1
    v_max_u32_dpp v11, v11, v11 quad_perm:[1,0,3,2] row_mask:0xf bank_mask:0xf
    s_nop 1
    v_max_u32_dpp v11, v11, v11 quad_perm:[2,3,0,1] row_mask:0xf bank_mask:0xf
    s_nop 1
    v_max_u32_dpp v11, v11, v11 row_half_mirror row_mask:0xf bank_mask:0xf
    s_lshl_b32 s50, s47, 5
    s_add_u32 s50, s50, 4096
    v_mov_b32 v10, s48
    v_mov_b32 v13, 0
    s_mov_b32 s56, 0
L_spin_1:
    ds_read_b32 v12, v7
    s_add_u32 s56, s56, 1
    s_waitcnt lgkmcnt(0)
    v_cmp_gt_u32 vcc, 1, v12
    s_cmp_gt_u32 s56, 2000000
    s_cbranch_scc1 L_spinx_2
    s_cbranch_vccnz L_spin_1
L_spinx_2:
    s_waitcnt vmcnt(0)
    s_mov_b64 exec, 1
    buffer_store_dwordx2 v[10:11], v13, s[8:11], s50 offen sc1
    s_mov_b64 exec, -1
    s_branch L_a_slot
L_vproj:
    s_waitcnt lgkmcnt(12)
    v_mfma_f32_16x16x32_bf16 v[112:115], v[64:67], v[68:71], 0
    ds_read_b128 v[64:67], v3 offset:320
    ds_read_b64_tr_b16 v[68:69], v4 offset:5120
    ds_read_b64_tr_b16 v[70:71], v4 offset:5248
    s_waitcnt lgkmcnt(12)
    v_mfma_f32_16x16x32_bf16 v[112:115], v[72:75], v[76:79], v[112:115]
    ds_read_b128 v[72:75], v3 offset:384
    ds_read_b64_tr_b16 v[76:77], v4 offset:6144
    ds_read_b64_tr_b16 v[78:79], v4 offset:6272
    s_waitcnt lgkmcnt(12)
    v_mfma_f32_16x16x32_bf16 v[112:115], v[80:83], v[84:87], v[112:115]
    ds_read_b128 v[80:83], v3 offset:448
    ds_read_b64_tr_b16 v[84:85], v4 offset:7168
    ds_read_b64_tr_b16 v[86:87], v4 offset:7296
    s_waitcnt lgkmcnt(12)
    v_mfma_f32_16x16x32_bf16 v[112:115], v[88:91], v[92:95], v[112:115]
    ds_read_b128 v[88:91], v3 offset:512
    ds_read_b64_tr_b16 v[92:93], v4 offset:8192
    ds_read_b64_tr_b16 v[94:95], v4 offset:8320
    s_waitcnt lgkmcnt(12)
    v_mfma_f32_16x16x32_bf16 v[112:115], v[96:99], v[100:103], v[112:115]
    ds_read_b128 v[96:99], v3 offset:576
    ds_read_b64_tr_b16 v[100:101], v4 offset:9216
    ds_read_b64_tr_b16 v[102:103], v4 offset:9344
    s_waitcnt lgkmcnt(12)
    v_mfma_f32_16x16x32_bf16 v[112:115], v[64:67], v[68:71], v[112:115]
    ds_read_b128 v[64:67], v3 offset:640
    ds_read_b64_tr_b16 v[68:69], v4 offset:10240
    ds_read_b64_tr_b16 v[70:71], v4 offset:10368
    s_waitcnt lgkmcnt(12)
    v_mfma_f32_16x16x32_bf16 v[112:115], v[72:75], v[76:79], v[112:115]
    ds_read_b128 v[72:75], v3 offset:704
    ds_read_b64_tr_b16 v[76:77], v4 offset:11264
    ds_read_b64_tr_b16 v[78:79], v4 offset:11392
    s_waitcnt lgkmcnt(12)
    v_mfma_f32_16x16x32_bf16 v[112:115], v[80:83], v[84:87], v[112:115]
    ds_read_b128 v[80:83], v3 offset:768
    ds_read_b64_tr_b16 v[84:85], v4 offset:12288
    ds_read_b64_tr_b16 v[86:87], v4 offset:12416
    s_waitcnt lgkmcnt(12)
    v_mfma_f32_16x16x32_bf16 v[112:115], v[88:91], v[92:95], v[112:115]
    ds_read_b128 v[88:91], v3 offset:832
    ds_read_b64_tr_b16 v[92:93], v4 offset:13312
    ds_read_b64_tr_b16 v[94:95], v4 offset:13440
    s_waitcnt lgkmcnt(12)
    v_mfma_f32_16x16x32_bf16 v[112:115], v[96:99], v[100:103], v[112:115]
    ds_read_b128 v[96:99], v3 offset:896
    ds_read_b64_tr_b16 v[100:101], v4 offset:14336
    ds_read_b64_tr_b16 v[102:103], v4 offset:14464
    s_waitcnt lgkmcnt(12)
    v_mfma_f32_16x16x32_bf16 v[112:115], v[64:67], v[68:71], v[112:115]
    ds_read_b128 v[64:67], v3 offset:960
    ds_read_b64_tr_b16 v[68:69], v4 offset:15360
    ds_read_b64_tr_b16 v[70:71], v4 offset:15488
    s_waitcnt lgkmcnt(12)
    v_mfma_f32_16x16x32_bf16 v[112:115], v[72:75], v[76:79], v[112:115]
    s_waitcnt lgkmcnt(9)
    v_mfma_f32_16x16x32_bf16 v[112:115], v[80:83], v[84:87], v[112:115]
    s_waitcnt lgkmcnt(6)
    v_mfma_f32_16x16x32_bf16 v[112:115], v[88:91], v[92:95], v[112:115]
    s_waitcnt lgkmcnt(3)
    v_mfma_f32_16x16x32_bf16 v[112:115], v[96:99], v[100:103], v[112:115]
    s_waitcnt lgkmcnt(0)
    v_mfma_f32_16x16x32_bf16 v[112:115], v[64:67], v[68:71], v[112:115]
    s_lshr_b32 s50, s47, 2
    s_lshl_b32 s50, s50, 10
    s_and_b32 s51, s46, 3
    s_lshl_b32 s51, s51, 8
    s_add_u32 s50, s50, s51
    s_add_u32 s50, s50, 3211264
    s_nop 2
    v_cvt_pk_bf16_f32 v8, v112, v113
    v_cvt_pk_bf16_f32 v9, v114, v115
    s_mov_b32 exec_hi, 0
    buffer_store_dwordx2 v[8:9], v6, s[8:11], s50 offen sc1
    s_mov_b64 exec, -1
    v_mov_b32 v8, 1
    s_waitcnt vmcnt(0)
    ds_write_b32 v7, v8
    s_branch L_a_slot
L_a_slot:
    v_mov_b32 v12, 148672
    s_mov_b32 s56, 0
L_spin_3:
    ds_read_b32 v13, v12
    s_add_u32 s56, s56, 1
    s_waitcnt lgkmcnt(0)
    v_cmp_eq_u32 vcc, 0, v13
    s_cmp_gt_u32 s56, 2000000
    s_cbranch_scc1 L_spinx_4
    s_cbranch_vccnz L_spin_3
L_spinx_4:
    v_readfirstlane_b32 s58, v13
    s_and_b32 s57, s58, 7
    s_bfe_u32 s58, s58, 0x50003
    s_and_b32 s50, s57, 3
    s_and_b32 s51, s58, 3
    s_lshl2_add_u32 s45, s50, s51
    s_lshr_b32 s50, s57, 2
    s_lshr_b32 s51, s58, 2
    s_lshl3_add_u32 s46, s50, s51
    s_lshl4_add_u32 s47, s45, s46
    s_branch L_a_main
L_xn_store:
    ds_read_b128 v[64:67], v8 offset:0
    ds_read_b128 v[68:71], v8 offset:128
    ds_read_b128 v[72:75], v8 offset:256
    ds_read_b128 v[76:79], v8 offset:384
    s_sub_u32 s51, s44, 6
    s_lshr_b32 s50, s47, 2
    s_lshl_b32 s50, s50, 15
    s_lshl_b32 s52, s51, 14
    s_add_u32 s50, s50, s52
    s_and_b32 s52, s46, 3
    s_lshl_b32 s52, s52, 7
    s_add_u32 s50, s50, s52
    s_add_u32 s50, s50, 1048576
    s_waitcnt lgkmcnt(3)
    buffer_store_dwordx4 v[64:67], v9, s[8:11], s50 offen sc1
    s_add_u32 s50, s50, 4096
    s_waitcnt lgkmcnt(2)
    buffer_store_dwordx4 v[68:71], v9, s[8:11], s50 offen sc1
    s_add_u32 s50, s50, 4096
    s_waitcnt lgkmcnt(1)
    buffer_store_dwordx4 v[72:75], v9, s[8:11], s50 offen sc1
    s_add_u32 s50, s50, 4096
    s_waitcnt lgkmcnt(0)
    buffer_store_dwordx4 v[76:79], v9, s[8:11], s50 offen sc1
    s_lshl1_add_u32 s50, s47, s51
    s_lshl_b32 s50, s50, 7
    s_add_u32 s50, s50, 327680
    s_lshl_b32 s51, s51, 2
    s_add_u32 s51, s51, 148568
    v_mov_b32 v4, s48
    v_mov_b32 v3, 0
    v_mov_b32 v5, s51
    v_mov_b32 v6, 1
    s_waitcnt vmcnt(0)
    s_mov_b64 exec, 1
    buffer_store_dword v4, v3, s[8:11], s50 offen sc1
    s_mov_b64 exec, -1
    ds_write_b32 v5, v6
    v_mov_b32 v12, 148672
    s_mov_b32 s56, 0
L_spin_5:
    ds_read_b32 v13, v12
    s_add_u32 s56, s56, 1
    s_waitcnt lgkmcnt(0)
    v_cmp_eq_u32 vcc, 0, v13
    s_cmp_gt_u32 s56, 2000000
    s_cbranch_scc1 L_spinx_6
    s_cbranch_vccnz L_spin_5
L_spinx_6:
    v_readfirstlane_b32 s58, v13
    s_and_b32 s57, s58, 7
    s_bfe_u32 s58, s58, 0x50003
    s_and_b32 s50, s57, 3
    s_and_b32 s51, s58, 3
    s_lshl2_add_u32 s45, s50, s51
    s_lshr_b32 s50, s57, 2
    s_lshr_b32 s51, s58, 2
    s_lshl3_add_u32 s46, s50, s51
    s_lshl4_add_u32 s47, s45, s46
    v_mov_b32 v10, 1
    s_lshl_b32 s50, s79, 2
    s_add_u32 s50, s50, 148480
    v_mov_b32 v11, s50
    v_lshrrev_b32 v18, 2, v1
    v_lshlrev_b32 v18, 10, v18
    v_and_b32 v19, 3, v1
    v_lshl_add_u32 v17, v19, 4, v18
    s_lshl_b32 s54, s46, 6
    s_and_b32 s52, s79, 1
    s_lshl_b32 s51, s52, 14
    s_add_u32 m0, s51, 65536
    s_lshl1_add_u32 s55, s46, s45
    s_and_b32 s55, s55, 3
    s_lshl2_add_u32 s50, s52, s55
    s_add_u32 s50, s50, 0
    s_and_b32 s50, s50, 7
    s_lshl_b32 s50, s50, 16
    s_add_u32 s50, s50, s54
    buffer_load_dwordx4 v17, s[12:15], s50 offen lds
    s_add_u32 m0, m0, 1024
    s_add_u32 s50, s50, 16384
    buffer_load_dwordx4 v17, s[12:15], s50 offen lds
    s_add_u32 m0, m0, 1024
    s_add_u32 s50, s50, 16384
    buffer_load_dwordx4 v17, s[12:15], s50 offen lds
    s_add_u32 m0, m0, 1024
    s_add_u32 s50, s50, 16384
    buffer_load_dwordx4 v17, s[12:15], s50 offen lds
    s_add_u32 m0, m0, 1024
    s_lshl2_add_u32 s50, s52, s55
    s_add_u32 s50, s50, 1
    s_and_b32 s50, s50, 7
    s_lshl_b32 s50, s50, 16
    s_add_u32 s50, s50, s54
    buffer_load_dwordx4 v17, s[12:15], s50 offen lds
    s_add_u32 m0, m0, 1024
    s_add_u32 s50, s50, 16384
    buffer_load_dwordx4 v17, s[12:15], s50 offen lds
    s_add_u32 m0, m0, 1024
    s_add_u32 s50, s50, 16384
    buffer_load_dwordx4 v17, s[12:15], s50 offen lds
    s_add_u32 m0, m0, 1024
    s_add_u32 s50, s50, 16384
    buffer_load_dwordx4 v17, s[12:15], s50 offen lds
    s_add_u32 m0, m0, 1024
    s_lshl2_add_u32 s50, s52, s55
    s_add_u32 s50, s50, 2
    s_and_b32 s50, s50, 7
    s_lshl_b32 s50, s50, 16
    s_add_u32 s50, s50, s54
    buffer_load_dwordx4 v17, s[12:15], s50 offen lds
    s_add_u32 m0, m0, 1024
    s_add_u32 s50, s50, 16384
    buffer_load_dwordx4 v17, s[12:15], s50 offen lds
    s_add_u32 m0, m0, 1024
    s_add_u32 s50, s50, 16384
    buffer_load_dwordx4 v17, s[12:15], s50 offen lds
    s_add_u32 m0, m0, 1024
    s_add_u32 s50, s50, 16384
    buffer_load_dwordx4 v17, s[12:15], s50 offen lds
    s_add_u32 m0, m0, 1024
    s_lshl2_add_u32 s50, s52, s55
    s_add_u32 s50, s50, 3
    s_and_b32 s50, s50, 7
    s_lshl_b32 s50, s50, 16
    s_add_u32 s50, s50, s54
    buffer_load_dwordx4 v17, s[12:15], s50 offen lds
    s_add_u32 m0, m0, 1024
    s_add_u32 s50, s50, 16384
    buffer_load_dwordx4 v17, s[12:15], s50 offen lds
    s_add_u32 m0, m0, 1024
    s_add_u32 s50, s50, 16384
    buffer_load_dwordx4 v17, s[12:15], s50 offen lds
    s_add_u32 m0, m0, 1024
    s_add_u32 s50, s50, 16384
    buffer_load_dwordx4 v17, s[12:15], s50 offen lds
L_a_main:
    v_and_b32 v10, 31, v1
    v_cmp_eq_u32 vcc, 16, v10
    v_mov_b32 v11, 0x3f803f80
    v_mov_b32 v27, 0xdddddddd
    v_cndmask_b32 v11, 0, v11, vcc
    v_mov_b32 v32, v11
    v_mov_b32 v33, v11
    v_mov_b32 v34, v11
    v_mov_b32 v35, v11
    v_mov_b32 v36, v11
    v_mov_b32 v37, v11
    v_mov_b32 v38, v11
    v_mov_b32 v39, v11
    v_mov_b32 v44, v11
    v_mov_b32 v45, v11
    v_mov_b32 v46, v11
    v_mov_b32 v47, v11
    v_mov_b32 v48, v11
    v_mov_b32 v49, v11
    v_mov_b32 v50, v11
    v_mov_b32 v51, v11
    v_mov_b32 v56, v11
    v_mov_b32 v57, v11
    v_mov_b32 v58, v11
    v_mov_b32 v59, v11
    v_mov_b32 v60, v11
    v_mov_b32 v61, v11
    v_mov_b32 v62, v11
    v_mov_b32 v63, v11
    v_and_b32 v10, 15, v1
    v_lshlrev_b32 v10, 4, v10
    v_lshrrev_b32 v11, 5, v1
    v_lshl_add_u32 v10, v11, 8, v10
    v_add_u32 v26, 65536, v10
    v_lshlrev_b32 v10, 2, v1
    s_add_u32 s50, s79, 1
    s_and_b32 s50, s50, 3
    s_mul_i32 s50, s50, 13824
    s_add_u32 s50, s50, 0
    v_add_u32 v20, s50, v2
    v_add_u32 v23, s50, v10
    s_add_u32 s50, s79, 2
    s_and_b32 s50, s50, 3
    s_mul_i32 s50, s50, 13824
    s_add_u32 s50, s50, 4608
    v_add_u32 v21, s50, v2
    v_add_u32 v24, s50, v10
    s_add_u32 s50, s79, 3
    s_and_b32 s50, s50, 3
    s_mul_i32 s50, s50, 13824
    s_add_u32 s50, s50, 9216
    v_add_u32 v22, s50, v2
    v_add_u32 v25, s50, v10
    s_mul_i32 s50, s79, 13824
    v_add_u32 v18, s50, v2
    v_add_u32 v19, s50, v10
    v_and_b32 v10, 3, v1
    v_lshlrev_b32 v10, 2, v10
    v_add_u32 v16, 148480, v10
    s_lshl_b32 s50, s79, 2
    s_add_u32 s50, s50, 148480
    v_mov_b32 v17, s50
    v_mov_b32 v128, 0
    v_mov_b32 v129, 0
    v_mov_b32 v130, 0
    v_mov_b32 v131, 0
    v_mov_b32 v132, 0
    v_mov_b32 v133, 0
    v_mov_b32 v134, 0
    v_mov_b32 v135, 0
    v_mov_b32 v136, 0
    v_mov_b32 v137, 0
    v_mov_b32 v138, 0
    v_mov_b32 v139, 0
    v_mov_b32 v140, 0
    v_mov_b32 v141, 0
    v_mov_b32 v142, 0
    v_mov_b32 v143, 0
    v_mov_b32 v144, 0
    v_mov_b32 v145, 0
    v_mov_b32 v146, 0
    v_mov_b32 v147, 0
    v_mov_b32 v148, 0
    v_mov_b32 v149, 0
    v_mov_b32 v150, 0
    v_mov_b32 v151, 0
    v_mov_b32 v152, 0
    v_mov_b32 v153, 0
    v_mov_b32 v154, 0
    v_mov_b32 v155, 0
    v_mov_b32 v156, 0
    v_mov_b32 v157, 0
    v_mov_b32 v158, 0
    v_mov_b32 v159, 0
    v_mov_b32 v160, 0
    v_mov_b32 v161, 0
    v_mov_b32 v162, 0
    v_mov_b32 v163, 0
    v_mov_b32 v164, 0
    v_mov_b32 v165, 0
    v_mov_b32 v166, 0
    v_mov_b32 v167, 0
    v_mov_b32 v168, 0
    v_mov_b32 v169, 0
    v_mov_b32 v170, 0
    v_mov_b32 v171, 0
    v_mov_b32 v172, 0
    v_mov_b32 v173, 0
    v_mov_b32 v174, 0
    v_mov_b32 v175, 0
    v_mov_b32 v176, 0
    v_mov_b32 v177, 0
    v_mov_b32 v178, 0
    v_mov_b32 v179, 0
    v_mov_b32 v180, 0
    v_mov_b32 v181, 0
    v_mov_b32 v182, 0
    v_mov_b32 v183, 0
    v_mov_b32 v184, 0
    v_mov_b32 v185, 0
    v_mov_b32 v186, 0
    v_mov_b32 v187, 0
    v_mov_b32 v188, 0
    v_mov_b32 v189, 0
    v_mov_b32 v190, 0
    v_mov_b32 v191, 0
    v_mov_b32 v192, 0
    v_mov_b32 v193, 0
    v_mov_b32 v194, 0
    v_mov_b32 v195, 0
    v_mov_b32 v196, 0
    v_mov_b32 v197, 0
    v_mov_b32 v198, 0
    v_mov_b32 v199, 0
    v_mov_b32 v200, 0
    v_mov_b32 v201, 0
    v_mov_b32 v202, 0
    v_mov_b32 v203, 0
    v_mov_b32 v204, 0
    v_mov_b32 v205, 0
    v_mov_b32 v206, 0
    v_mov_b32 v207, 0
    v_mov_b32 v208, 0
    v_mov_b32 v209, 0
    v_mov_b32 v210, 0
    v_mov_b32 v211, 0
    v_mov_b32 v212, 0
    v_mov_b32 v213, 0
    v_mov_b32 v214, 0
    v_mov_b32 v215, 0
    v_mov_b32 v216, 0
    v_mov_b32 v217, 0
    v_mov_b32 v218, 0
    v_mov_b32 v219, 0
    v_mov_b32 v220, 0
    v_mov_b32 v221, 0
    v_mov_b32 v222, 0
    v_mov_b32 v223, 0
    v_mov_b32 v224, 0
    v_mov_b32 v225, 0
    v_mov_b32 v226, 0
    v_mov_b32 v227, 0
    v_mov_b32 v228, 0
    v_mov_b32 v229, 0
    v_mov_b32 v230, 0
    v_mov_b32 v231, 0
    v_mov_b32 v232, 0
    v_mov_b32 v233, 0
    v_mov_b32 v234, 0
    v_mov_b32 v235, 0
    v_mov_b32 v236, 0
    v_mov_b32 v237, 0
    v_mov_b32 v238, 0
    v_mov_b32 v239, 0
    v_mov_b32 v240, 0
    v_mov_b32 v241, 0
    v_mov_b32 v242, 0
    v_mov_b32 v243, 0
    v_mov_b32 v244, 0
    v_mov_b32 v245, 0
    v_mov_b32 v246, 0
    v_mov_b32 v247, 0
    v_mov_b32 v248, 0
    v_mov_b32 v249, 0
    v_mov_b32 v250, 0
    v_mov_b32 v251, 0
    v_mov_b32 v252, 0
    v_mov_b32 v253, 0
    v_mov_b32 v254, 0
    v_mov_b32 v255, 0
    s_mov_b32 s60, 0xffff
    s_mov_b32 s61, 0xffff
    s_lshl_b32 s100, s79, 14
    s_add_u32 s100, s100, 3145728
    s_lshl1_add_u32 s3, s57, s58
    s_and_b32 s3, s3, 15
    s_lshl_b32 s78, s3, 10
    s_add_u32 s78, s78, s100
    v_mov_b32 v88, 0
    v_mov_b32 v89, 0
    v_mov_b32 v90, 0
    v_mov_b32 v91, 0
    v_mov_b32 v92, 0
    v_mov_b32 v93, 0
    v_mov_b32 v94, 0
    v_mov_b32 v95, 0
    s_lshl1_add_u32 s50, s79, 0
    s_and_b32 s50, s50, 7
    s_lshl_b32 s50, s50, 10
    s_add_u32 s50, s50, 140288
    v_add_u32 v64, s50, v2
    s_lshl1_add_u32 s50, s79, 1
    s_and_b32 s50, s50, 7
    s_lshl_b32 s50, s50, 10
    s_add_u32 s50, s50, 140288
    v_add_u32 v65, s50, v2
    s_lshl1_add_u32 s50, s79, 2
    s_and_b32 s50, s50, 7
    s_lshl_b32 s50, s50, 10
    s_add_u32 s50, s50, 140288
    v_add_u32 v66, s50, v2
    s_lshl1_add_u32 s50, s79, 3
    s_and_b32 s50, s50, 7
    s_lshl_b32 s50, s50, 10
    s_add_u32 s50, s50, 140288
    v_add_u32 v67, s50, v2
    s_lshl1_add_u32 s50, s79, 4
    s_and_b32 s50, s50, 7
    s_lshl_b32 s50, s50, 10
    s_add_u32 s50, s50, 140288
    v_add_u32 v68, s50, v2
    s_lshl1_add_u32 s50, s79, 5
    s_and_b32 s50, s50, 7
    s_lshl_b32 s50, s50, 10
    s_add_u32 s50, s50, 140288
    v_add_u32 v69, s50, v2
    s_lshl1_add_u32 s50, s79, 6
    s_and_b32 s50, s50, 7
    s_lshl_b32 s50, s50, 10
    s_add_u32 s50, s50, 140288
    v_add_u32 v70, s50, v2
    s_lshl1_add_u32 s50, s79, 7
    s_and_b32 s50, s50, 7
    s_lshl_b32 s50, s50, 10
    s_add_u32 s50, s50, 140288
    v_add_u32 v71, s50, v2
    v_lshlrev_b32 v3, 5, v1
    s_lshl_b32 s52, s79, 11
    s_add_u32 s52, s52, 4096
    v_and_b32 v7, 7, v1
    v_lshlrev_b32 v7, 2, v7
    v_add_u32 v7, 148496, v7
    s_cmp_lt_u32 s44, 6
    s_cbranch_scc1 L_nowq_7
    v_mov_b32 v9, 1
    s_waitcnt vmcnt(0)
    ds_write_b32 v17, v9 offset:56
L_nowq_7:
    s_mov_b32 s56, 0
L_spin_8:
    ds_read_b32 v8, v17 offset:96
    s_add_u32 s56, s56, 1
    s_waitcnt lgkmcnt(0)
    v_cmp_gt_u32 vcc, 1, v8
    s_cmp_gt_u32 s56, 2000000
    s_cbranch_scc1 L_spinx_9
    s_cbranch_vccnz L_spin_8
L_spinx_9:
    s_mov_b32 s56, 0
L_poll_10:
    buffer_load_dwordx2 v[4:5], v3, s[8:11], s52 offen sc1
    s_add_u32 s56, s56, 1
    s_waitcnt vmcnt(0)
    v_cmp_ne_u32 vcc, s48, v4
    s_cmp_gt_u32 s56, 200000
    s_cbranch_scc1 L_pollx_11
    s_cbranch_vccnz L_poll_10
L_pollx_11:
    buffer_load_dwordx4 v[28:31], v2, s[8:11], s78 offen sc1
    s_mov_b64 exec, s[60:61]
    buffer_load_dwordx4 v[32:35], v26, s[8:11], s78 offen sc1
    buffer_load_dwordx4 v[36:39], v26, s[8:11], s78 offen offset:512 sc1
    s_mov_b64 exec, -1
    s_add_u32 s3, s3, 1
    s_and_b32 s3, s3, 15
    s_lshl_b32 s78, s3, 10
    s_add_u32 s78, s78, s100
    buffer_load_dwordx4 v[40:43], v2, s[8:11], s78 offen sc1
    s_mov_b64 exec, s[60:61]
    buffer_load_dwordx4 v[44:47], v26, s[8:11], s78 offen sc1
    buffer_load_dwordx4 v[48:51], v26, s[8:11], s78 offen offset:512 sc1
    s_mov_b64 exec, -1
    s_add_u32 s3, s3, 1
    s_and_b32 s3, s3, 15
    s_lshl_b32 s78, s3, 10
    s_add_u32 s78, s78, s100
    buffer_load_dwordx4 v[52:55], v2, s[8:11], s78 offen sc1
    s_nop 1
    v_max_u32_dpp v5, v5, v5 quad_perm:[1,0,3,2] row_mask:0xf bank_mask:0xf
    s_nop 1
    v_max_u32_dpp v5, v5, v5 quad_perm:[2,3,0,1] row_mask:0xf bank_mask:0xf
    s_nop 1
    v_max_u32_dpp v5, v5, v5 row_half_mirror row_mask:0xf bank_mask:0xf
    s_nop 1
    v_max_u32_dpp v5, v5, v5 row_mirror row_mask:0xf bank_mask:0xf
    v_mov_b32 v6, v5
    s_nop 1
    v_permlane16_swap_b32 v5, v6
    v_max_u32 v5, v5, v6
    v_mov_b32 v6, v5
    s_nop 1
    v_permlane32_swap_b32 v5, v6
    v_max_u32 v5, v5, v6
    ds_write_b32 v17, v5 offset:32
    s_mov_b32 s56, 0
L_spin_13:
    ds_read_b32 v8, v7
    s_add_u32 s56, s56, 1
    s_waitcnt lgkmcnt(0)
    v_cmp_eq_u32 vcc, -1, v8
    s_cmp_gt_u32 s56, 2000000
    s_cbranch_scc1 L_spinx_14
    s_cbranch_vccnz L_spin_13
L_spinx_14:
    ds_read_b128 v[96:99], v64
    ds_read_b128 v[100:103], v65
    ds_read_b128 v[104:107], v66
    ds_read_b128 v[108:111], v67
    ds_read_b128 v[112:115], v68
    ds_read_b128 v[116:119], v69
    ds_read_b128 v[120:123], v70
    ds_read_b128 v[124:127], v71
    s_or_b32 s50, s47, s79
    s_cmp_lg_u32 s50, 0
    s_cbranch_scc1 L_noep_15
    v_mov_b32 v9, s48
    v_mov_b32 v3, 0
    s_mov_b32 s50, 0
    s_mov_b64 exec, 1
    buffer_store_dword v9, v3, s[8:11], s50 offen sc1
    s_mov_b64 exec, -1
L_noep_15:
    s_nop 1
    v_max_u32_dpp v8, v8, v8 quad_perm:[1,0,3,2] row_mask:0xf bank_mask:0xf
    s_nop 1
    v_max_u32_dpp v8, v8, v8 quad_perm:[2,3,0,1] row_mask:0xf bank_mask:0xf
    s_nop 1
    v_mov_b32_dpp v9, v8 row_half_mirror row_mask:0xf bank_mask:0xf
    v_mul_f32 v8, v8, v9
    v_cmp_nge_f32 vcc, 0x45610000, v8
    s_cbranch_vccnz L_a_slow
    s_setprio 1
    v_mov_b32 v9, 1
    ds_write_b32 v17, v9 offset:128
    s_waitcnt vmcnt(4) lgkmcnt(0)
    v_mfma_f32_32x32x16_bf16 v[64:79], v[28:31], v[96:99], 0
    s_mov_b32 s56, 5
    s_nop 7
    s_nop 2
.p2align 3
L_a_loop:
    v_exp_f32 v64, v64
    v_exp_f32 v65, v65
    v_smfmac_f32_32x32x32_bf16 v[240:255], v[60:63], v[88:95], v27
    v_exp_f32 v66, v66
    v_exp_f32 v67, v67
    v_exp_f32 v68, v68
    v_mfma_f32_32x32x16_bf16 v[80:95], v[28:31], v[100:103], 0
    v_exp_f32 v69, v69
    v_exp_f32 v70, v70
    v_exp_f32 v71, v71
    v_exp_f32 v72, v72
    v_exp_f32 v73, v73
    v_exp_f32 v74, v74
    v_exp_f32 v75, v75
    v_exp_f32 v76, v76
    v_exp_f32 v77, v77
    v_smfmac_f32_32x32x32_bf16 v[128:143], v[32:35], v[64:71], v27
    v_exp_f32 v78, v78
    v_exp_f32 v79, v79
    v_exp_f32 v80, v80
    v_exp_f32 v81, v81
    v_smfmac_f32_32x32x32_bf16 v[128:143], v[36:39], v[72:79], v27
    v_exp_f32 v82, v82
    v_exp_f32 v83, v83
    v_exp_f32 v84, v84
    v_mfma_f32_32x32x16_bf16 v[64:79], v[28:31], v[104:107], 0
    v_exp_f32 v85, v85
    v_exp_f32 v86, v86
    v_exp_f32 v87, v87
    v_exp_f32 v88, v88
    v_exp_f32 v89, v89
    v_exp_f32 v90, v90
    v_exp_f32 v91, v91
    v_exp_f32 v92, v92
    v_exp_f32 v93, v93
    v_smfmac_f32_32x32x32_bf16 v[144:159], v[32:35], v[80:87], v27
    v_exp_f32 v94, v94
    v_exp_f32 v95, v95
    v_exp_f32 v64, v64
    v_exp_f32 v65, v65
    v_smfmac_f32_32x32x32_bf16 v[144:159], v[36:39], v[88:95], v27
    v_exp_f32 v66, v66
    v_exp_f32 v67, v67
    v_exp_f32 v68, v68
    v_mfma_f32_32x32x16_bf16 v[80:95], v[28:31], v[108:111], 0
    v_exp_f32 v69, v69
    v_exp_f32 v70, v70
    v_exp_f32 v71, v71
    v_exp_f32 v72, v72
    v_exp_f32 v73, v73
    v_exp_f32 v74, v74
    v_exp_f32 v75, v75
    v_exp_f32 v76, v76
    v_exp_f32 v77, v77
    v_smfmac_f32_32x32x32_bf16 v[160:175], v[32:35], v[64:71], v27
    v_exp_f32 v78, v78
    v_exp_f32 v79, v79
    v_exp_f32 v80, v80
    v_exp_f32 v81, v81
    v_smfmac_f32_32x32x32_bf16 v[160:175], v[36:39], v[72:79], v27
    v_exp_f32 v82, v82
    v_exp_f32 v83, v83
    v_exp_f32 v84, v84
    v_mfma_f32_32x32x16_bf16 v[64:79], v[28:31], v[112:115], 0
    v_exp_f32 v85, v85
    v_exp_f32 v86, v86
    v_exp_f32 v87, v87
    v_exp_f32 v88, v88
    v_exp_f32 v89, v89
    v_exp_f32 v90, v90
    v_exp_f32 v91, v91
    v_exp_f32 v92, v92
    v_exp_f32 v93, v93
    v_smfmac_f32_32x32x32_bf16 v[176:191], v[32:35], v[80:87], v27
    v_exp_f32 v94, v94
    v_exp_f32 v95, v95
    v_exp_f32 v64, v64
    v_exp_f32 v65, v65
    v_smfmac_f32_32x32x32_bf16 v[176:191], v[36:39], v[88:95], v27
    v_exp_f32 v66, v66
    v_exp_f32 v67, v67
    v_exp_f32 v68, v68
    v_mfma_f32_32x32x16_bf16 v[80:95], v[28:31], v[116:119], 0
    v_exp_f32 v69, v69
    v_exp_f32 v70, v70
    v_exp_f32 v71, v71
    v_exp_f32 v72, v72
    v_exp_f32 v73, v73
    v_exp_f32 v74, v74
    v_exp_f32 v75, v75
    v_exp_f32 v76, v76
    v_exp_f32 v77, v77
    v_smfmac_f32_32x32x32_bf16 v[192:207], v[32:35], v[64:71], v27
    s_mov_b64 exec, s[60:61]
    buffer_load_dwordx4 v[56:59], v26, s[8:11], s78 offen sc1
    buffer_load_dwordx4 v[60:63], v26, s[8:11], s78 offen offset:512 sc1
    s_mov_b64 exec, -1
    v_exp_f32 v78, v78
    v_exp_f32 v79, v79
    v_exp_f32 v80, v80
    v_exp_f32 v81, v81
    v_smfmac_f32_32x32x32_bf16 v[192:207], v[36:39], v[72:79], v27
    v_exp_f32 v82, v82
    v_exp_f32 v83, v83
    v_exp_f32 v84, v84
    v_mfma_f32_32x32x16_bf16 v[64:79], v[28:31], v[120:123], 0
    v_exp_f32 v85, v85
    v_exp_f32 v86, v86
    v_exp_f32 v87, v87
    v_exp_f32 v88, v88
    v_exp_f32 v89, v89
    v_exp_f32 v90, v90
    v_exp_f32 v91, v91
    v_exp_f32 v92, v92
    v_exp_f32 v93, v93
    v_smfmac_f32_32x32x32_bf16 v[208:223], v[32:35], v[80:87], v27
    v_exp_f32 v94, v94
    v_exp_f32 v95, v95
    v_exp_f32 v64, v64
    v_exp_f32 v65, v65
    v_smfmac_f32_32x32x32_bf16 v[208:223], v[36:39], v[88:95], v27
    v_exp_f32 v66, v66
    v_exp_f32 v67, v67
    v_exp_f32 v68, v68
    v_mfma_f32_32x32x16_bf16 v[80:95], v[28:31], v[124:127], 0
    v_exp_f32 v69, v69
    v_exp_f32 v70, v70
    v_exp_f32 v71, v71
    v_exp_f32 v72, v72
    v_exp_f32 v73, v73
    v_exp_f32 v74, v74
    v_exp_f32 v75, v75
    v_exp_f32 v76, v76
    v_exp_f32 v77, v77
    v_smfmac_f32_32x32x32_bf16 v[224:239], v[32:35], v[64:71], v27
    v_exp_f32 v78, v78
    v_exp_f32 v79, v79
    v_exp_f32 v80, v80
    v_exp_f32 v81, v81
    v_smfmac_f32_32x32x32_bf16 v[224:239], v[36:39], v[72:79], v27
    v_exp_f32 v82, v82
    v_exp_f32 v83, v83
    v_exp_f32 v84, v84
    s_waitcnt vmcnt(3)
    v_mfma_f32_32x32x16_bf16 v[64:79], v[40:43], v[96:99], 0
    v_exp_f32 v85, v85
    s_add_u32 s3, s3, 1
    v_exp_f32 v86, v86
    s_and_b32 s3, s3, 15
    v_exp_f32 v87, v87
    s_lshl_b32 s78, s3, 10
    v_exp_f32 v88, v88
    s_add_u32 s78, s78, s100
    v_exp_f32 v89, v89
    v_exp_f32 v90, v90
    v_exp_f32 v91, v91
    v_exp_f32 v92, v92
    v_exp_f32 v93, v93
    v_smfmac_f32_32x32x32_bf16 v[240:255], v[32:35], v[80:87], v27
    buffer_load_dwordx4 v[28:31], v2, s[8:11], s78 offen sc1
    v_exp_f32 v94, v94
    v_exp_f32 v95, v95
    v_exp_f32 v64, v64
    v_exp_f32 v65, v65
    v_smfmac_f32_32x32x32_bf16 v[240:255], v[36:39], v[88:95], v27
    v_exp_f32 v66, v66
    v_exp_f32 v67, v67
    v_exp_f32 v68, v68
    v_mfma_f32_32x32x16_bf16 v[80:95], v[40:43], v[100:103], 0
    v_exp_f32 v69, v69
    v_exp_f32 v70, v70
    v_exp_f32 v71, v71
    v_exp_f32 v72, v72
    v_exp_f32 v73, v73
    v_exp_f32 v74, v74
    v_exp_f32 v75, v75
    v_exp_f32 v76, v76
    v_exp_f32 v77, v77
    v_smfmac_f32_32x32x32_bf16 v[128:143], v[44:47], v[64:71], v27
    v_exp_f32 v78, v78
    v_exp_f32 v79, v79
    v_exp_f32 v80, v80
    v_exp_f32 v81, v81
    v_smfmac_f32_32x32x32_bf16 v[128:143], v[48:51], v[72:79], v27
    v_exp_f32 v82, v82
    v_exp_f32 v83, v83
    v_exp_f32 v84, v84
    v_mfma_f32_32x32x16_bf16 v[64:79], v[40:43], v[104:107], 0
    v_exp_f32 v85, v85
    v_exp_f32 v86, v86
    v_exp_f32 v87, v87
    v_exp_f32 v88, v88
    v_exp_f32 v89, v89
    v_exp_f32 v90, v90
    v_exp_f32 v91, v91
    v_exp_f32 v92, v92
    v_exp_f32 v93, v93
    v_smfmac_f32_32x32x32_bf16 v[144:159], v[44:47], v[80:87], v27
    v_exp_f32 v94, v94
    v_exp_f32 v95, v95
    v_exp_f32 v64, v64
    v_exp_f32 v65, v65
    v_smfmac_f32_32x32x32_bf16 v[144:159], v[48:51], v[88:95], v27
    v_exp_f32 v66, v66
    v_exp_f32 v67, v67
    v_exp_f32 v68, v68
    v_mfma_f32_32x32x16_bf16 v[80:95], v[40:43], v[108:111], 0
    v_exp_f32 v69, v69
    v_exp_f32 v70, v70
    v_exp_f32 v71, v71
    v_exp_f32 v72, v72
    v_exp_f32 v73, v73
    v_exp_f32 v74, v74
    v_exp_f32 v75, v75
    v_exp_f32 v76, v76
    v_exp_f32 v77, v77
    v_smfmac_f32_32x32x32_bf16 v[160:175], v[44:47], v[64:71], v27
    v_exp_f32 v78, v78
    v_exp_f32 v79, v79
    v_exp_f32 v80, v80
    v_exp_f32 v81, v81
    v_smfmac_f32_32x32x32_bf16 v[160:175], v[48:51], v[72:79], v27
    v_exp_f32 v82, v82
    v_exp_f32 v83, v83
    v_exp_f32 v84, v84
    v_mfma_f32_32x32x16_bf16 v[64:79], v[40:43], v[112:115], 0
    v_exp_f32 v85, v85
    v_exp_f32 v86, v86
    v_exp_f32 v87, v87
    v_exp_f32 v88, v88
    v_exp_f32 v89, v89
    v_exp_f32 v90, v90
    v_exp_f32 v91, v91
    v_exp_f32 v92, v92
    v_exp_f32 v93, v93
    v_smfmac_f32_32x32x32_bf16 v[176:191], v[44:47], v[80:87], v27
    v_exp_f32 v94, v94
    v_exp_f32 v95, v95
    v_exp_f32 v64, v64
    v_exp_f32 v65, v65
    v_smfmac_f32_32x32x32_bf16 v[176:191], v[48:51], v[88:95], v27
    v_exp_f32 v66, v66
    v_exp_f32 v67, v67
    v_exp_f32 v68, v68
    v_mfma_f32_32x32x16_bf16 v[80:95], v[40:43], v[116:119], 0
    v_exp_f32 v69, v69
    v_exp_f32 v70, v70
    v_exp_f32 v71, v71
    v_exp_f32 v72, v72
    v_exp_f32 v73, v73
    v_exp_f32 v74, v74
    v_exp_f32 v75, v75
    v_exp_f32 v76, v76
    v_exp_f32 v77, v77
    v_smfmac_f32_32x32x32_bf16 v[192:207], v[44:47], v[64:71], v27
    s_mov_b64 exec, s[60:61]
    buffer_load_dwordx4 v[32:35], v26, s[8:11], s78 offen sc1
    buffer_load_dwordx4 v[36:39], v26, s[8:11], s78 offen offset:512 sc1
    s_mov_b64 exec, -1
    v_exp_f32 v78, v78
    v_exp_f32 v79, v79
    v_exp_f32 v80, v80
    v_exp_f32 v81, v81
    v_smfmac_f32_32x32x32_bf16 v[192:207], v[48:51], v[72:79], v27
    v_exp_f32 v82, v82
    v_exp_f32 v83, v83
    v_exp_f32 v84, v84
    v_mfma_f32_32x32x16_bf16 v[64:79], v[40:43], v[120:123], 0
    v_exp_f32 v85, v85
    v_exp_f32 v86, v86
    v_exp_f32 v87, v87
    v_exp_f32 v88, v88
    v_exp_f32 v89, v89
    v_exp_f32 v90, v90
    v_exp_f32 v91, v91
    v_exp_f32 v92, v92
    v_exp_f32 v93, v93
    v_smfmac_f32_32x32x32_bf16 v[208:223], v[44:47], v[80:87], v27
    v_exp_f32 v94, v94
    v_exp_f32 v95, v95
    v_exp_f32 v64, v64
    v_exp_f32 v65, v65
    v_smfmac_f32_32x32x32_bf16 v[208:223], v[48:51], v[88:95], v27
    v_exp_f32 v66, v66
    v_exp_f32 v67, v67
    v_exp_f32 v68, v68
    v_mfma_f32_32x32x16_bf16 v[80:95], v[40:43], v[124:127], 0
    v_exp_f32 v69, v69
    v_exp_f32 v70, v70
    v_exp_f32 v71, v71
    v_exp_f32 v72, v72
    v_exp_f32 v73, v73
    v_exp_f32 v74, v74
    v_exp_f32 v75, v75
    v_exp_f32 v76, v76
    v_exp_f32 v77, v77
    v_smfmac_f32_32x32x32_bf16 v[224:239], v[44:47], v[64:71], v27
    v_exp_f32 v78, v78
    v_exp_f32 v79, v79
    v_exp_f32 v80, v80
    v_exp_f32 v81, v81
    v_smfmac_f32_32x32x32_bf16 v[224:239], v[48:51], v[72:79], v27
    v_exp_f32 v82, v82
    v_exp_f32 v83, v83
    v_exp_f32 v84, v84
    s_waitcnt vmcnt(3)
    v_mfma_f32_32x32x16_bf16 v[64:79], v[52:55], v[96:99], 0
    v_exp_f32 v85, v85
    s_add_u32 s3, s3, 1
    v_exp_f32 v86, v86
    s_and_b32 s3, s3, 15
    v_exp_f32 v87, v87
    s_lshl_b32 s78, s3, 10
    v_exp_f32 v88, v88
    s_add_u32 s78, s78, s100
    v_exp_f32 v89, v89
    v_exp_f32 v90, v90
    v_exp_f32 v91, v91
    v_exp_f32 v92, v92
    v_exp_f32 v93, v93
    v_smfmac_f32_32x32x32_bf16 v[240:255], v[44:47], v[80:87], v27
    buffer_load_dwordx4 v[40:43], v2, s[8:11], s78 offen sc1
    v_exp_f32 v94, v94
    v_exp_f32 v95, v95
    v_exp_f32 v64, v64
    v_exp_f32 v65, v65
    v_smfmac_f32_32x32x32_bf16 v[240:255], v[48:51], v[88:95], v27
    v_exp_f32 v66, v66
    v_exp_f32 v67, v67
    v_exp_f32 v68, v68
    v_mfma_f32_32x32x16_bf16 v[80:95], v[52:55], v[100:103], 0
    v_exp_f32 v69, v69
    v_exp_f32 v70, v70
    v_exp_f32 v71, v71
    v_exp_f32 v72, v72
    v_exp_f32 v73, v73
    v_exp_f32 v74, v74
    v_exp_f32 v75, v75
    v_exp_f32 v76, v76
    v_exp_f32 v77, v77
    v_smfmac_f32_32x32x32_bf16 v[128:143], v[56:59], v[64:71], v27
    v_exp_f32 v78, v78
    v_exp_f32 v79, v79
    v_exp_f32 v80, v80
    v_exp_f32 v81, v81
    v_smfmac_f32_32x32x32_bf16 v[128:143], v[60:63], v[72:79], v27
    v_exp_f32 v82, v82
    v_exp_f32 v83, v83
    v_exp_f32 v84, v84
    v_mfma_f32_32x32x16_bf16 v[64:79], v[52:55], v[104:107], 0
    v_exp_f32 v85, v85
    v_exp_f32 v86, v86
    v_exp_f32 v87, v87
    v_exp_f32 v88, v88
    v_exp_f32 v89, v89
    v_exp_f32 v90, v90
    v_exp_f32 v91, v91
    v_exp_f32 v92, v92
    v_exp_f32 v93, v93
    v_smfmac_f32_32x32x32_bf16 v[144:159], v[56:59], v[80:87], v27
    v_exp_f32 v94, v94
    v_exp_f32 v95, v95
    v_exp_f32 v64, v64
    v_exp_f32 v65, v65
    v_smfmac_f32_32x32x32_bf16 v[144:159], v[60:63], v[88:95], v27
    v_exp_f32 v66, v66
    v_exp_f32 v67, v67
    v_exp_f32 v68, v68
    v_mfma_f32_32x32x16_bf16 v[80:95], v[52:55], v[108:111], 0
    v_exp_f32 v69, v69
    v_exp_f32 v70, v70
    v_exp_f32 v71, v71
    v_exp_f32 v72, v72
    v_exp_f32 v73, v73
    v_exp_f32 v74, v74
    v_exp_f32 v75, v75
    v_exp_f32 v76, v76
    v_exp_f32 v77, v77
    v_smfmac_f32_32x32x32_bf16 v[160:175], v[56:59], v[64:71], v27
    v_exp_f32 v78, v78
    v_exp_f32 v79, v79
    v_exp_f32 v80, v80
    v_exp_f32 v81, v81
    v_smfmac_f32_32x32x32_bf16 v[160:175], v[60:63], v[72:79], v27
    v_exp_f32 v82, v82
    v_exp_f32 v83, v83
    v_exp_f32 v84, v84
    v_mfma_f32_32x32x16_bf16 v[64:79], v[52:55], v[112:115], 0
    v_exp_f32 v85, v85
    v_exp_f32 v86, v86
    v_exp_f32 v87, v87
    v_exp_f32 v88, v88
    v_exp_f32 v89, v89
    v_exp_f32 v90, v90
    v_exp_f32 v91, v91
    v_exp_f32 v92, v92
    v_exp_f32 v93, v93
    v_smfmac_f32_32x32x32_bf16 v[176:191], v[56:59], v[80:87], v27
    v_exp_f32 v94, v94
    v_exp_f32 v95, v95
    v_exp_f32 v64, v64
    v_exp_f32 v65, v65
    v_smfmac_f32_32x32x32_bf16 v[176:191], v[60:63], v[88:95], v27
    v_exp_f32 v66, v66
    v_exp_f32 v67, v67
    v_exp_f32 v68, v68
    v_mfma_f32_32x32x16_bf16 v[80:95], v[52:55], v[116:119], 0
    v_exp_f32 v69, v69
    v_exp_f32 v70, v70
    v_exp_f32 v71, v71
    v_exp_f32 v72, v72
    v_exp_f32 v73, v73
    v_exp_f32 v74, v74
    v_exp_f32 v75, v75
    v_exp_f32 v76, v76
    v_exp_f32 v77, v77
    v_smfmac_f32_32x32x32_bf16 v[192:207], v[56:59], v[64:71], v27
    s_mov_b64 exec, s[60:61]
    buffer_load_dwordx4 v[44:47], v26, s[8:11], s78 offen sc1
    buffer_load_dwordx4 v[48:51], v26, s[8:11], s78 offen offset:512 sc1
    s_mov_b64 exec, -1
    v_exp_f32 v78, v78
    v_exp_f32 v79, v79
    v_exp_f32 v80, v80
    v_exp_f32 v81, v81
    v_smfmac_f32_32x32x32_bf16 v[192:207], v[60:63], v[72:79], v27
    v_exp_f32 v82, v82
    v_exp_f32 v83, v83
    v_exp_f32 v84, v84
    v_mfma_f32_32x32x16_bf16 v[64:79], v[52:55], v[120:123], 0
    v_exp_f32 v85, v85
    v_exp_f32 v86, v86
    v_exp_f32 v87, v87
    v_exp_f32 v88, v88
    v_exp_f32 v89, v89
    v_exp_f32 v90, v90
    v_exp_f32 v91, v91
    v_exp_f32 v92, v92
    v_exp_f32 v93, v93
    v_smfmac_f32_32x32x32_bf16 v[208:223], v[56:59], v[80:87], v27
    v_exp_f32 v94, v94
    v_exp_f32 v95, v95
    v_exp_f32 v64, v64
    v_exp_f32 v65, v65
    v_smfmac_f32_32x32x32_bf16 v[208:223], v[60:63], v[88:95], v27
    v_exp_f32 v66, v66
    v_exp_f32 v67, v67
    v_exp_f32 v68, v68
    v_mfma_f32_32x32x16_bf16 v[80:95], v[52:55], v[124:127], 0
    v_exp_f32 v69, v69
    v_exp_f32 v70, v70
    v_exp_f32 v71, v71
    v_exp_f32 v72, v72
    v_exp_f32 v73, v73
    v_exp_f32 v74, v74
    v_exp_f32 v75, v75
    v_exp_f32 v76, v76
    v_exp_f32 v77, v77
    v_smfmac_f32_32x32x32_bf16 v[224:239], v[56:59], v[64:71], v27
    v_exp_f32 v78, v78
    v_exp_f32 v79, v79
    v_exp_f32 v80, v80
    v_exp_f32 v81, v81
    v_smfmac_f32_32x32x32_bf16 v[224:239], v[60:63], v[72:79], v27
    v_exp_f32 v82, v82
    v_exp_f32 v83, v83
    v_exp_f32 v84, v84
    s_waitcnt vmcnt(3)
    v_mfma_f32_32x32x16_bf16 v[64:79], v[28:31], v[96:99], 0
    v_exp_f32 v85, v85
    s_add_u32 s3, s3, 1
    v_exp_f32 v86, v86
    s_and_b32 s3, s3, 15
    v_exp_f32 v87, v87
    s_lshl_b32 s78, s3, 10
    v_exp_f32 v88, v88
    s_add_u32 s78, s78, s100
    v_exp_f32 v89, v89
    v_exp_f32 v90, v90
    v_exp_f32 v91, v91
    s_sub_u32 s56, s56, 1
    v_exp_f32 v92, v92
    v_exp_f32 v93, v93
    v_smfmac_f32_32x32x32_bf16 v[240:255], v[56:59], v[80:87], v27
    buffer_load_dwordx4 v[52:55], v2, s[8:11], s78 offen sc1
    v_exp_f32 v94, v94
    s_cmp_lg_u32 s56, 0
    v_exp_f32 v95, v95
    s_cbranch_scc1 L_a_loop
    ds_read_b32 v8, v16
    v_exp_f32 v64, v64
    v_exp_f32 v65, v65
    v_smfmac_f32_32x32x32_bf16 v[240:255], v[60:63], v[88:95], v27
    v_exp_f32 v66, v66
    v_exp_f32 v67, v67
    v_exp_f32 v68, v68
    v_mfma_f32_32x32x16_bf16 v[80:95], v[28:31], v[104:107], 0
    v_exp_f32 v69, v69
    v_exp_f32 v70, v70
    v_exp_f32 v71, v71
    v_exp_f32 v72, v72
    v_exp_f32 v73, v73
    v_exp_f32 v74, v74
    v_exp_f32 v75, v75
    v_exp_f32 v76, v76
    v_exp_f32 v77, v77
    v_smfmac_f32_32x32x32_bf16 v[128:143], v[32:35], v[64:71], v27
    v_exp_f32 v78, v78
    v_exp_f32 v79, v79
    s_waitcnt lgkmcnt(0)
    s_mov_b32 s56, 0
    v_cmp_gt_u32 vcc, 17, v8
    s_cbranch_vccz L_spinx_17
L_spin_16:
    ds_read_b32 v8, v16
    s_add_u32 s56, s56, 1
    s_waitcnt lgkmcnt(0)
    v_cmp_gt_u32 vcc, 17, v8
    s_cmp_gt_u32 s56, 2000000
    s_cbranch_scc1 L_spinx_17
    s_cbranch_vccnz L_spin_16
L_spinx_17:
    v_exp_f32 v80, v80
    v_exp_f32 v81, v81
    v_smfmac_f32_32x32x32_bf16 v[128:143], v[36:39], v[72:79], v27
    v_exp_f32 v82, v82
    v_exp_f32 v83, v83
    v_exp_f32 v84, v84
    v_mfma_f32_32x32x16_bf16 v[64:79], v[28:31], v[108:111], 0
    v_exp_f32 v85, v85
    v_exp_f32 v86, v86
    v_exp_f32 v87, v87
    v_exp_f32 v88, v88
    v_exp_f32 v89, v89
    v_exp_f32 v90, v90
    v_exp_f32 v91, v91
    v_exp_f32 v92, v92
    v_exp_f32 v93, v93
    v_smfmac_f32_32x32x32_bf16 v[160:175], v[32:35], v[80:87], v27
    v_exp_f32 v94, v94
    v_exp_f32 v95, v95
    v_exp_f32 v64, v64
    v_exp_f32 v65, v65
    v_smfmac_f32_32x32x32_bf16 v[160:175], v[36:39], v[88:95], v27
    v_exp_f32 v66, v66
    v_exp_f32 v67, v67
    v_exp_f32 v68, v68
    v_mfma_f32_32x32x16_bf16 v[80:95], v[28:31], v[112:115], 0
    v_exp_f32 v69, v69
    v_exp_f32 v70, v70
    v_exp_f32 v71, v71
    v_exp_f32 v72, v72
    v_exp_f32 v73, v73
    v_exp_f32 v74, v74
    v_exp_f32 v75, v75
    v_exp_f32 v76, v76
    v_exp_f32 v77, v77
    v_smfmac_f32_32x32x32_bf16 v[176:191], v[32:35], v[64:71], v27
    v_exp_f32 v78, v78
    v_exp_f32 v79, v79
    v_exp_f32 v80, v80
    v_exp_f32 v81, v81
    v_smfmac_f32_32x32x32_bf16 v[176:191], v[36:39], v[72:79], v27
    v_exp_f32 v82, v82
    v_exp_f32 v83, v83
    ds_write_b128 v20, v[160:163] offset:0
    v_exp_f32 v84, v84
    v_mfma_f32_32x32x16_bf16 v[64:79], v[28:31], v[116:119], 0
    v_exp_f32 v85, v85
    v_exp_f32 v86, v86
    v_exp_f32 v87, v87
    ds_write_b128 v20, v[164:167] offset:1024
    v_exp_f32 v88, v88
    v_exp_f32 v89, v89
    v_exp_f32 v90, v90
    v_exp_f32 v91, v91
    v_exp_f32 v92, v92
    ds_write_b32 v23, v168 offset:2048
    v_exp_f32 v93, v93
    v_smfmac_f32_32x32x32_bf16 v[192:207], v[32:35], v[80:87], v27
    v_exp_f32 v94, v94
    v_exp_f32 v95, v95
    v_exp_f32 v64, v64
    v_exp_f32 v65, v65
    v_smfmac_f32_32x32x32_bf16 v[192:207], v[36:39], v[88:95], v27
    v_exp_f32 v66, v66
    v_exp_f32 v67, v67
    ds_write_b128 v20, v[176:179] offset:2304
    v_exp_f32 v68, v68
    v_mfma_f32_32x32x16_bf16 v[80:95], v[28:31], v[120:123], 0
    v_exp_f32 v69, v69
    v_exp_f32 v70, v70
    v_exp_f32 v71, v71
    ds_write_b128 v20, v[180:183] offset:3328
    v_exp_f32 v72, v72
    v_exp_f32 v73, v73
    v_exp_f32 v74, v74
    v_exp_f32 v75, v75
    v_exp_f32 v76, v76
    ds_write_b32 v23, v184 offset:4352
    v_exp_f32 v77, v77
    v_smfmac_f32_32x32x32_bf16 v[208:223], v[32:35], v[64:71], v27
    v_exp_f32 v78, v78
    v_exp_f32 v79, v79
    v_exp_f32 v80, v80
    v_exp_f32 v81, v81
    v_smfmac_f32_32x32x32_bf16 v[208:223], v[36:39], v[72:79], v27
    v_exp_f32 v82, v82
    v_exp_f32 v83, v83
    ds_write_b128 v21, v[192:195] offset:0
    v_exp_f32 v84, v84
    v_mfma_f32_32x32x16_bf16 v[64:79], v[28:31], v[124:127], 0
    v_exp_f32 v85, v85
    v_exp_f32 v86, v86
    v_exp_f32 v87, v87
    ds_write_b128 v21, v[196:199] offset:1024
    v_exp_f32 v88, v88
    v_exp_f32 v89, v89
    v_exp_f32 v90, v90
    v_exp_f32 v91, v91
    v_exp_f32 v92, v92
    ds_write_b32 v24, v200 offset:2048
    v_exp_f32 v93, v93
    v_smfmac_f32_32x32x32_bf16 v[224:239], v[32:35], v[80:87], v27
    v_exp_f32 v94, v94
    v_exp_f32 v95, v95
    v_exp_f32 v64, v64
    v_exp_f32 v65, v65
    v_smfmac_f32_32x32x32_bf16 v[224:239], v[36:39], v[88:95], v27
    v_exp_f32 v66, v66
    v_exp_f32 v67, v67
    ds_write_b128 v21, v[208:211] offset:2304
    v_exp_f32 v68, v68
    v_mfma_f32_32x32x16_bf16 v[80:95], v[28:31], v[100:103], 0
    v_exp_f32 v69, v69
    v_exp_f32 v70, v70
    v_exp_f32 v71, v71
    ds_write_b128 v21, v[212:215] offset:3328
    v_exp_f32 v72, v72
    v_exp_f32 v73, v73
    v_exp_f32 v74, v74
    v_exp_f32 v75, v75
    v_exp_f32 v76, v76
    ds_write_b32 v24, v216 offset:4352
    v_exp_f32 v77, v77
    v_smfmac_f32_32x32x32_bf16 v[240:255], v[32:35], v[64:71], v27
    v_exp_f32 v78, v78
    v_exp_f32 v79, v79
    v_exp_f32 v80, v80
    v_exp_f32 v81, v81
    v_smfmac_f32_32x32x32_bf16 v[240:255], v[36:39], v[72:79], v27
    v_exp_f32 v82, v82
    v_exp_f32 v83, v83
    ds_write_b128 v22, v[224:227] offset:0
    v_exp_f32 v84, v84
    v_exp_f32 v85, v85
    v_exp_f32 v86, v86
    v_exp_f32 v87, v87
    ds_write_b128 v22, v[228:231] offset:1024
    v_exp_f32 v88, v88
    v_exp_f32 v89, v89
    v_exp_f32 v90, v90
    v_exp_f32 v91, v91
    v_exp_f32 v92, v92
    ds_write_b32 v25, v232 offset:2048
    v_exp_f32 v93, v93
    v_smfmac_f32_32x32x32_bf16 v[144:159], v[32:35], v[80:87], v27
    v_exp_f32 v94, v94
    v_exp_f32 v95, v95
    s_nop 1
    v_smfmac_f32_32x32x32_bf16 v[144:159], v[36:39], v[88:95], v27
    ds_write_b128 v22, v[240:243] offset:2304
    ds_write_b128 v22, v[244:247] offset:3328
    ds_write_b32 v25, v248 offset:4352
    s_branch L_a_merge
L_a_merge_full:
    s_mov_b32 s56, 0
L_spin_18:
    ds_read_b32 v8, v16
    s_add_u32 s56, s56, 1
    s_waitcnt lgkmcnt(0)
    v_cmp_gt_u32 vcc, 17, v8
    s_cmp_gt_u32 s56, 2000000
    s_cbranch_scc1 L_spinx_19
    s_cbranch_vccnz L_spin_18
L_spinx_19:
    s_nop 7
    ds_write_b128 v20, v[160:163] offset:0
    ds_write_b128 v20, v[164:167] offset:1024
    ds_write_b32 v23, v168 offset:2048
    ds_write_b128 v20, v[176:179] offset:2304
    ds_write_b128 v20, v[180:183] offset:3328
    ds_write_b32 v23, v184 offset:4352
    ds_write_b128 v21, v[192:195] offset:0
    ds_write_b128 v21, v[196:199] offset:1024
    ds_write_b32 v24, v200 offset:2048
    ds_write_b128 v21, v[208:211] offset:2304
    ds_write_b128 v21, v[212:215] offset:3328
    ds_write_b32 v24, v216 offset:4352
    ds_write_b128 v22, v[224:227] offset:0
    ds_write_b128 v22, v[228:231] offset:1024
    ds_write_b32 v25, v232 offset:2048
    ds_write_b128 v22, v[240:243] offset:2304
    ds_write_b128 v22, v[244:247] offset:3328
    ds_write_b32 v25, v248 offset:4352
L_a_merge:
    v_mov_b32 v9, 1
    s_lshl2_add_u32 s50, s45, s79
    s_lshl_b32 s50, s50, 5
    s_lshl1_add_u32 s50, s46, s50
    s_lshl_b32 s50, s50, 10
    s_add_u32 s50, s50, 4194304
    s_lshl2_add_u32 s51, s47, s79
    s_lshl_b32 s51, s51, 7
    s_add_u32 s51, s51, 196608
    s_waitcnt lgkmcnt(0)
    ds_write_b32 v17, v9 offset:48
    s_mov_b32 s56, 0
L_spin_20:
    ds_read_b32 v8, v16 offset:48
    s_add_u32 s56, s56, 1
    s_waitcnt lgkmcnt(0)
    v_cmp_gt_u32 vcc, 1, v8
    s_cmp_gt_u32 s56, 2000000
    s_cbranch_scc1 L_spinx_21
    s_cbranch_vccnz L_spin_20
L_spinx_21:
    ds_read_b128 v[64:67], v18 offset:0
    ds_read_b128 v[68:71], v18 offset:1024
    ds_read_b32 v72, v19 offset:2048
    ds_read_b128 v[74:77], v18 offset:2304
    ds_read_b128 v[78:81], v18 offset:3328
    ds_read_b32 v82, v19 offset:4352
    ds_read_b128 v[84:87], v18 offset:4608
    ds_read_b128 v[88:91], v18 offset:5632
    ds_read_b32 v92, v19 offset:6656
    ds_read_b128 v[94:97], v18 offset:6912
    ds_read_b128 v[98:101], v18 offset:7936
    ds_read_b32 v102, v19 offset:8960
    s_waitcnt lgkmcnt(6)
    v_pk_add_f32 v[128:129], v[128:129], v[64:65]
    v_pk_add_f32 v[130:131], v[130:131], v[66:67]
    v_pk_add_f32 v[132:133], v[132:133], v[68:69]
    v_pk_add_f32 v[134:135], v[134:135], v[70:71]
    v_add_f32 v136, v136, v72
    v_pk_add_f32 v[144:145], v[144:145], v[74:75]
    v_pk_add_f32 v[146:147], v[146:147], v[76:77]
    v_pk_add_f32 v[148:149], v[148:149], v[78:79]
    v_pk_add_f32 v[150:151], v[150:151], v[80:81]
    v_add_f32 v152, v152, v82
    ds_read_b128 v[104:107], v18 offset:9216
    ds_read_b128 v[108:111], v18 offset:10240
    ds_read_b32 v112, v19 offset:11264
    ds_read_b128 v[114:117], v18 offset:11520
    ds_read_b128 v[118:121], v18 offset:12544
    ds_read_b32 v122, v19 offset:13568
    s_waitcnt lgkmcnt(6)
    v_pk_add_f32 v[128:129], v[128:129], v[84:85]
    v_pk_add_f32 v[130:131], v[130:131], v[86:87]
    v_pk_add_f32 v[132:133], v[132:133], v[88:89]
    v_pk_add_f32 v[134:135], v[134:135], v[90:91]
    v_add_f32 v136, v136, v92
    v_pk_add_f32 v[144:145], v[144:145], v[94:95]
    v_pk_add_f32 v[146:147], v[146:147], v[96:97]
    v_pk_add_f32 v[148:149], v[148:149], v[98:99]
    v_pk_add_f32 v[150:151], v[150:151], v[100:101]
    v_add_f32 v152, v152, v102
    v_mov_b32 v16, s48
    v_mov_b32 v17, 0
    s_waitcnt lgkmcnt(0)
    v_pk_add_f32 v[128:129], v[128:129], v[104:105]
    v_pk_add_f32 v[130:131], v[130:131], v[106:107]
    v_pk_add_f32 v[132:133], v[132:133], v[108:109]
    v_pk_add_f32 v[134:135], v[134:135], v[110:111]
    v_add_f32 v136, v136, v112
    v_pk_add_f32 v[144:145], v[144:145], v[114:115]
    v_pk_add_f32 v[146:147], v[146:147], v[116:117]
    v_pk_add_f32 v[148:149], v[148:149], v[118:119]
    v_pk_add_f32 v[150:151], v[150:151], v[120:121]
    v_add_f32 v152, v152, v122
    v_mov_b32 v14, v136
    v_mov_b32 v15, v152
    s_nop 0
    v_permlane32_swap_b32 v136, v14
    v_permlane32_swap_b32 v152, v15
    v_rcp_f32 v14, v136
    v_rcp_f32 v18, v152
    s_nop 0
    v_pk_mul_f32 v[128:129], v[128:129], v[14:15] op_sel_hi:[1,0]
    v_pk_mul_f32 v[130:131], v[130:131], v[14:15] op_sel_hi:[1,0]
    v_pk_mul_f32 v[132:133], v[132:133], v[14:15] op_sel_hi:[1,0]
    v_pk_mul_f32 v[134:135], v[134:135], v[14:15] op_sel_hi:[1,0]
    v_cvt_pk_bf16_f32 v20, v128, v129
    v_cvt_pk_bf16_f32 v21, v130, v131
    v_cvt_pk_bf16_f32 v22, v132, v133
    v_cvt_pk_bf16_f32 v23, v134, v135
    buffer_store_dwordx4 v[20:23], v2, s[8:11], s50 offen offset:0 sc1
    v_pk_mul_f32 v[144:145], v[144:145], v[18:19] op_sel_hi:[1,0]
    v_pk_mul_f32 v[146:147], v[146:147], v[18:19] op_sel_hi:[1,0]
    v_pk_mul_f32 v[148:149], v[148:149], v[18:19] op_sel_hi:[1,0]
    v_pk_mul_f32 v[150:151], v[150:151], v[18:19] op_sel_hi:[1,0]
    v_cvt_pk_bf16_f32 v24, v144, v145
    v_cvt_pk_bf16_f32 v25, v146, v147
    v_cvt_pk_bf16_f32 v26, v148, v149
    v_cvt_pk_bf16_f32 v27, v150, v151
    buffer_store_dwordx4 v[24:27], v2, s[8:11], s50 offen offset:1024 sc1
    s_waitcnt vmcnt(0)
    s_mov_b64 exec, 1
    buffer_store_dword v16, v17, s[8:11], s51 offen sc1
    s_endpgm
L_g_early:
    s_sub_u32 s80, s80, L_pc-parallel_sum__grouped_kv_mqa__glu_gated_swiglu__prompt_kernel
    s_subb_u32 s81, s81, 0
    s_and_b32 s50, s58, 31
    s_lshl2_add_u32 s50, s50, s44
    s_mul_i32 s50, s50, 384
    s_mov_b64 exec, 0x7
    v_lshlrev_b32 v18, 7, v1
    v_add_u32 v18, s50, v18
    v_min_u32 v18, L_code_end-parallel_sum__grouped_kv_mqa__glu_gated_swiglu__prompt_kernel-4, v18
    v_mov_b32 v19, s81
    v_add_co_u32 v18, vcc, s80, v18
    s_nop 1
    v_addc_co_u32 v19, vcc, 0, v19, vcc
    global_load_dword v47, v[18:19], off
    s_mov_b64 exec, -1
    s_sub_u32 s50, s2, 1
    s_and_b32 s50, s50, s2
    s_xor_b32 s51, s44, 1
    s_or_b32 s50, s50, s51
    s_cmp_lg_u32 s50, 0
    s_cbranch_scc1 L_noxt_22
    s_ff1_i32_b32 s51, s2
    s_add_u32 s51, s51, 1
    s_lshl_b32 s51, s51, 7
    s_add_u32 s51, s51, 40960
    s_getreg_b32 s52, hwreg(HW_REG_XCC_ID, 0, 4)
    s_waitcnt lgkmcnt(0)
    s_mul_i32 s53, s48, 0x9E3779B1
    s_add_u32 s53, s53, 0x7F4A7C15
    v_mov_b32 v20, s53
    v_mov_b32 v21, s52
    v_mov_b32 v22, 0
    s_mov_b64 exec, 1
    buffer_store_dwordx2 v[20:21], v22, s[8:11], s51 offen sc1
    s_mov_b64 exec, -1
L_noxt_22:
    v_lshrrev_b32 v18, 2, v1
    v_lshlrev_b32 v18, 10, v18
    v_and_b32 v19, 3, v1
    v_lshl_add_u32 v17, v19, 4, v18
    s_waitcnt vmcnt(1)
    s_branch L_ln
L_g_bar1:
    v_mov_b32 v44, s48
    s_cmp_lg_u32 s44, 0
    s_cbranch_scc1 L_nopk_23
    v_lshlrev_b32 v16, 7, v1
    s_mov_b32 s53, 40960
    s_mov_b64 exec, 0x1ff
    buffer_load_dwordx2 v[46:47], v16, s[8:11], s53 offen sc1
    s_mov_b64 exec, -1
    s_barrier
    s_setprio 2
    s_mov_b32 s53, 40960
    s_waitcnt vmcnt(0)
    s_mov_b32 s56, 0
    s_mov_b64 exec, 0x1ff
    v_cmp_ne_u32 vcc, s48, v46
    s_cbranch_vccz L_pollx_26
L_poll_25:
    buffer_load_dwordx2 v[46:47], v16, s[8:11], s53 offen sc1
    s_add_u32 s56, s56, 1
    s_waitcnt vmcnt(0)
    v_cmp_ne_u32 vcc, s48, v46
    s_cmp_gt_u32 s56, 200000
    s_cbranch_scc1 L_pollx_26
    s_cbranch_vccnz L_poll_25
L_pollx_26:
    s_mov_b64 exec, -1
    v_readlane_b32 s71, v47, 0
    s_mov_b32 s62, 0
    s_mov_b32 s63, 0
    s_mov_b32 s64, 0
    s_mov_b32 s65, 0
    s_mov_b32 s66, 0
    s_mov_b32 s67, 0
    v_readlane_b32 s68, v47, 1
    s_sub_u32 s68, s68, s71
    s_and_b32 s68, s68, 7
    s_bitcmp1_b32 s2, 0
    s_cselect_b32 s69, s68, 0
    s_xor_b32 s65, s65, s69
    s_xor_b32 s69, s68, s62
    s_min_u32 s68, s68, s69
    s_xor_b32 s69, s68, s63
    s_min_u32 s68, s68, s69
    s_xor_b32 s69, s68, s64
    s_min_u32 s68, s68, s69
    s_cmp_ge_u32 s68, 4
    s_cselect_b32 s62, s68, s62
    s_lshr_b32 s69, s68, 1
    s_cmp_eq_u32 s69, 1
    s_cselect_b32 s63, s68, s63
    s_cmp_eq_u32 s68, 1
    s_cselect_b32 s64, 1, s64
    s_cmp_eq_u32 s68, 0
    s_cselect_b32 s69, 1, 0
    s_lshr_b32 s70, s2, 0
    s_and_b32 s70, s70, s69
    s_lshl_b32 s70, s70, s67
    s_or_b32 s66, s66, s70
    s_add_u32 s67, s67, s69
    v_readlane_b32 s68, v47, 2
    s_sub_u32 s68, s68, s71
    s_and_b32 s68, s68, 7
    s_bitcmp1_b32 s2, 1
    s_cselect_b32 s69, s68, 0
    s_xor_b32 s65, s65, s69
    s_xor_b32 s69, s68, s62
    s_min_u32 s68, s68, s69
    s_xor_b32 s69, s68, s63
    s_min_u32 s68, s68, s69
    s_xor_b32 s69, s68, s64
    s_min_u32 s68, s68, s69
    s_cmp_ge_u32 s68, 4
    s_cselect_b32 s62, s68, s62
    s_lshr_b32 s69, s68, 1
    s_cmp_eq_u32 s69, 1
    s_cselect_b32 s63, s68, s63
    s_cmp_eq_u32 s68, 1
    s_cselect_b32 s64, 1, s64
    s_cmp_eq_u32 s68, 0
    s_cselect_b32 s69, 1, 0
    s_lshr_b32 s70, s2, 1
    s_and_b32 s70, s70, s69
    s_lshl_b32 s70, s70, s67
    s_or_b32 s66, s66, s70
    s_add_u32 s67, s67, s69
    v_readlane_b32 s68, v47, 3
    s_sub_u32 s68, s68, s71
    s_and_b32 s68, s68, 7
    s_bitcmp1_b32 s2, 2
    s_cselect_b32 s69, s68, 0
    s_xor_b32 s65, s65, s69
    s_xor_b32 s69, s68, s62
    s_min_u32 s68, s68, s69
    s_xor_b32 s69, s68, s63
    s_min_u32 s68, s68, s69
    s_xor_b32 s69, s68, s64
    s_min_u32 s68, s68, s69
    s_cmp_ge_u32 s68, 4
    s_cselect_b32 s62, s68, s62
    s_lshr_b32 s69, s68, 1
    s_cmp_eq_u32 s69, 1
    s_cselect_b32 s63, s68, s63
    s_cmp_eq_u32 s68, 1
    s_cselect_b32 s64, 1, s64
    s_cmp_eq_u32 s68, 0
    s_cselect_b32 s69, 1, 0
    s_lshr_b32 s70, s2, 2
    s_and_b32 s70, s70, s69
    s_lshl_b32 s70, s70, s67
    s_or_b32 s66, s66, s70
    s_add_u32 s67, s67, s69
    v_readlane_b32 s68, v47, 4
    s_sub_u32 s68, s68, s71
    s_and_b32 s68, s68, 7
    s_bitcmp1_b32 s2, 3
    s_cselect_b32 s69, s68, 0
    s_xor_b32 s65, s65, s69
    s_xor_b32 s69, s68, s62
    s_min_u32 s68, s68, s69
    s_xor_b32 s69, s68, s63
    s_min_u32 s68, s68, s69
    s_xor_b32 s69, s68, s64
    s_min_u32 s68, s68, s69
    s_cmp_ge_u32 s68, 4
    s_cselect_b32 s62, s68, s62
    s_lshr_b32 s69, s68, 1
    s_cmp_eq_u32 s69, 1
    s_cselect_b32 s63, s68, s63
    s_cmp_eq_u32 s68, 1
    s_cselect_b32 s64, 1, s64
    s_cmp_eq_u32 s68, 0
    s_cselect_b32 s69, 1, 0
    s_lshr_b32 s70, s2, 3
    s_and_b32 s70, s70, s69
    s_lshl_b32 s70, s70, s67
    s_or_b32 s66, s66, s70
    s_add_u32 s67, s67, s69
    v_readlane_b32 s68, v47, 5
    s_sub_u32 s68, s68, s71
    s_and_b32 s68, s68, 7
    s_bitcmp1_b32 s2, 4
    s_cselect_b32 s69, s68, 0
    s_xor_b32 s65, s65, s69
    s_xor_b32 s69, s68, s62
    s_min_u32 s68, s68, s69
    s_xor_b32 s69, s68, s63
    s_min_u32 s68, s68, s69
    s_xor_b32 s69, s68, s64
    s_min_u32 s68, s68, s69
    s_cmp_ge_u32 s68, 4
    s_cselect_b32 s62, s68, s62
    s_lshr_b32 s69, s68, 1
    s_cmp_eq_u32 s69, 1
    s_cselect_b32 s63, s68, s63
    s_cmp_eq_u32 s68, 1
    s_cselect_b32 s64, 1, s64
    s_cmp_eq_u32 s68, 0
    s_cselect_b32 s69, 1, 0
    s_lshr_b32 s70, s2, 4
    s_and_b32 s70, s70, s69
    s_lshl_b32 s70, s70, s67
    s_or_b32 s66, s66, s70
    s_add_u32 s67, s67, s69
    v_readlane_b32 s68, v47, 6
    s_sub_u32 s68, s68, s71
    s_and_b32 s68, s68, 7
    s_bitcmp1_b32 s2, 5
    s_cselect_b32 s69, s68, 0
    s_xor_b32 s65, s65, s69
    s_xor_b32 s69, s68, s62
    s_min_u32 s68, s68, s69
    s_xor_b32 s69, s68, s63
    s_min_u32 s68, s68, s69
    s_xor_b32 s69, s68, s64
    s_min_u32 s68, s68, s69
    s_cmp_ge_u32 s68, 4
    s_cselect_b32 s62, s68, s62
    s_lshr_b32 s69, s68, 1
    s_cmp_eq_u32 s69, 1
    s_cselect_b32 s63, s68, s63
    s_cmp_eq_u32 s68, 1
    s_cselect_b32 s64, 1, s64
    s_cmp_eq_u32 s68, 0
    s_cselect_b32 s69, 1, 0
    s_lshr_b32 s70, s2, 5
    s_and_b32 s70, s70, s69
    s_lshl_b32 s70, s70, s67
    s_or_b32 s66, s66, s70
    s_add_u32 s67, s67, s69
    v_readlane_b32 s68, v47, 7
    s_sub_u32 s68, s68, s71
    s_and_b32 s68, s68, 7
    s_bitcmp1_b32 s2, 6
    s_cselect_b32 s69, s68, 0
    s_xor_b32 s65, s65, s69
    v_readlane_b32 s68, v47, 8
    s_sub_u32 s68, s68, s71
    s_and_b32 s68, s68, 7
    s_bitcmp1_b32 s2, 7
    s_cselect_b32 s69, s68, 0
    s_xor_b32 s65, s65, s69
    s_lshr_b32 s69, s2, 6
    s_lshl3_add_u32 s66, s69, s66
    s_lshl3_add_u32 s65, s66, s65
    s_cmp_eq_u32 s67, 3
    s_cselect_b32 s65, s65, s2
    s_or_b32 s65, s65, 0x100
    v_mov_b32 v19, s65
    v_mov_b32 v18, 148672
    ds_write_b32 v18, v19
    s_branch L_slot_24
L_nopk_23:
    s_barrier
    s_setprio 2
L_slot_24:
    v_mov_b32 v18, 148672
    s_mov_b32 s56, 0
L_spin_28:
    ds_read_b32 v19, v18
    s_add_u32 s56, s56, 1
    s_waitcnt lgkmcnt(0)
    v_cmp_eq_u32 vcc, 0, v19
    s_cmp_gt_u32 s56, 2000000
    s_cbranch_scc1 L_spinx_29
    s_cbranch_vccnz L_spin_28
L_spinx_29:
    v_readfirstlane_b32 s58, v19
    s_and_b32 s57, s58, 7
    s_bfe_u32 s58, s58, 0x50003
    s_and_b32 s50, s57, 3
    s_and_b32 s51, s58, 3
    s_lshl2_add_u32 s45, s50, s51
    s_lshr_b32 s50, s57, 2
    s_lshr_b32 s51, s58, 2
    s_lshl3_add_u32 s46, s50, s51
    s_lshl4_add_u32 s47, s45, s46
    v_and_b32 v19, 3, v1
    v_bfe_u32 v20, v1, 1, 2
    v_bfe_u32 v21, v1, 4, 1
    v_xor_b32 v20, v20, v21
    v_lshrrev_b32 v22, 3, v1
    v_mul_u32_u24 v23, 3584, v22
    v_and_b32 v24, 1, v1
    v_lshl_add_u32 v23, v24, 4, v23
    v_lshl_add_u32 v3, v20, 5, v23
    v_xor_b32 v24, 2, v20
    v_lshl_add_u32 v4, v24, 5, v23
    v_mov_b32 v25, 0x40000000
    v_cmp_eq_u32 vcc, 3, v20
    v_cmp_eq_u32 s[52:53], 3, v24
    v_bfe_u32 v26, v1, 2, 1
    v_xor_b32 v26, v26, v21
    v_lshlrev_b32 v26, 6, v26
    v_lshl_add_u32 v26, v19, 4, v26
    v_cndmask_b32 v5, v3, v25, vcc
    v_cndmask_b32 v6, v4, v25, s[52:53]
    v_lshl_add_u32 v7, v22, 10, v26
    s_mul_i32 s68, s44, 57344
    s_lshl_b32 s50, s46, 7
    s_add_u32 s68, s68, s50
    s_lshl_b32 s50, s46, 5
    s_sub_u32 s78, 2048, s50
    s_sub_u32 s79, 64, s46
    s_lshl_b32 s79, s79, 10
    s_lshl_b32 s60, s44, 4
    s_mul_i32 s61, s44, 12
    s_add_u32 s61, s61, 64
    s_lshl_b32 s69, s44, 12
    s_lshl1_add_u32 s59, s46, s45
    s_and_b32 s59, s59, 3
    v_lshlrev_b32 v19, 3, v19
    v_bfe_u32 v20, v1, 2, 2
    v_lshrrev_b32 v22, 5, v1
    v_bfe_u32 v23, v1, 3, 1
    v_lshl_add_u32 v24, v22, 9, v19
    v_lshl_add_u32 v24, v20, 6, v24
    v_lshl_add_u32 v24, v21, 5, v24
    v_add_u32 v12, 65536, v24
    v_lshl_add_u32 v24, v21, 11, v19
    v_lshl_add_u32 v24, v22, 10, v24
    v_lshl_add_u32 v24, v20, 7, v24
    v_lshl_add_u32 v25, v21, 1, v23
    v_lshl_add_u32 v8, v25, 5, v24
    v_xor_b32 v9, 32, v8
    v_xor_b32 v10, 64, v8
    v_xor_b32 v11, 96, v8
    s_and_b32 s55, s58, 3
    s_lshl2_add_u32 s52, s57, s55
    s_lshr_b32 s2, s58, 2
    s_lshl_b32 s54, s2, 7
    s_mul_i32 s74, s44, 0
    s_add_u32 s74, s74, s54
    s_lshl_b32 s75, s44, 17
    s_add_u32 s75, s75, s54
    s_lshl_b32 s76, s44, 14
    s_add_u32 s76, s76, 65536
    s_lshl1_add_u32 s0, s55, s2
    s_lshl_b32 s0, s0, 1
    s_lshl1_add_u32 s0, s57, s0
    s_and_b32 s0, s0, 15
    s_lshl1_add_u32 s1, s55, s2
    s_mul_i32 s1, s1, 3
    s_lshr_b32 s1, s1, 1
    s_add_u32 s1, s1, s57
    s_sub_u32 s50, s1, 12
    s_cmp_ge_u32 s1, 12
    s_cselect_b32 s1, s50, s1
    s_sub_u32 s50, s1, 12
    s_cmp_ge_u32 s1, 12
    s_cselect_b32 s1, s50, s1
    s_lshr_b32 s50, s44, 1
    s_lshl1_add_u32 s50, s52, s50
    s_xor_b32 s51, s50, 1
    s_mul_i32 s55, s44, 0
    s_mul_i32 s70, s50, 112
    s_add_u32 s70, s70, s55
    s_lshl_b32 s70, s70, 10
    s_add_u32 s70, s70, 6291456
    s_lshl_b32 s72, s50, 2
    s_add_u32 s72, s72, s44
    s_lshl_b32 s72, s72, 13
    s_add_u32 s72, s72, 4194304
    s_mul_i32 s71, s51, 112
    s_add_u32 s71, s71, s55
    s_lshl_b32 s71, s71, 10
    s_add_u32 s71, s71, 6291456
    s_lshl_b32 s73, s51, 2
    s_add_u32 s73, s73, s44
    s_lshl_b32 s73, s73, 13
    s_add_u32 s73, s73, 4194304
    s_lshl_b32 s77, s50, 15
    s_add_u32 s77, s77, s54
    s_and_b32 s51, s44, 1
    s_lshl_b32 s51, s51, 6
    s_add_u32 s77, s77, s51
    v_lshl_add_u32 v24, v21, 5, v19
    v_lshl_add_u32 v24, v20, 7, v24
    v_lshl_add_u32 v24, v22, 9, v24
    v_lshl_add_u32 v24, v23, 6, v24
    v_xor_b32 v24, s51, v24
    v_add_u32 v40, s76, v24
    v_xor_b32 v41, 64, v40
    s_lshr_b32 s50, s52, 1
    s_lshl2_add_u32 s50, s50, s44
    s_lshl_b32 s50, s50, 4
    s_and_b32 s51, s52, 1
    s_lshl1_add_u32 s50, s51, s50
    s_lshl_b32 s50, s50, 7
    v_and_b32 v24, 3, v1
    v_lshlrev_b32 v25, 9, v24
    v_bfe_u32 v26, v1, 2, 1
    v_lshl_add_u32 v25, v26, 7, v25
    v_add_u32 v42, s50, v25
    v_and_b32 v25, 31, v1
    v_lshlrev_b32 v25, 10, v25
    v_lshl_add_u32 v43, v22, 3, v25
    v_lshrrev_b32 v24, 3, v1
    v_and_b32 v25, 7, v1
    v_xor_b32 v26, v25, v24
    v_lshlrev_b32 v26, 4, v26
    v_lshl_add_u32 v32, v24, 10, v26
    s_and_b32 s50, s44, 1
    s_lshl_b32 s50, s50, 2
    v_xor_b32 v25, s50, v25
    v_lshlrev_b32 v25, 4, v25
    v_and_b32 v24, 31, v1
    v_lshl_add_u32 v25, v24, 7, v25
    v_lshl_add_u32 v25, v22, 3, v25
    s_lshl_b32 s50, s44, 12
    s_add_u32 s50, s50, 131072
    v_add_u32 v33, s50, v25
    v_and_b32 v24, 3, v1
    v_lshlrev_b32 v24, 2, v24
    v_add_u32 v13, 148480, v24
    s_lshl_b32 s50, s44, 2
    s_add_u32 s50, s50, 148480
    v_mov_b32 v14, s50
    v_mov_b32 v0, 1
    v_mov_b32 v45, 0
    s_mov_b32 s62, 0xbfb8aa3b
    s_mov_b32 s63, 0xbfb8aa3b
    s_mov_b32 s64, 1.0
    s_mov_b32 s65, 1.0
    s_mov_b32 s66, 0x3eb8aa3b
    s_mov_b32 s67, 0x3eb8aa3b
    s_lshl2_add_u32 s50, s45, s44
    v_and_b32 v16, 7, v1
    v_lshlrev_b32 v16, 7, v16
    s_lshl_b32 s83, s50, 10
    s_add_u32 s83, s83, 327680
    s_lshl_b32 s82, s50, 15
    s_add_u32 s82, s82, 1048576
    s_mul_i32 s81, s50, 112
    s_mul_i32 s51, s46, 4
    s_add_u32 s81, s81, s51
    s_lshl_b32 s81, s81, 10
    s_add_u32 s81, s81, 6291456
    s_lshl2_add_u32 s101, s47, s44
    s_lshl_b32 s101, s101, 7
    s_add_u32 s101, s101, 65536
    s_mov_b32 s56, 0
    s_mov_b64 exec, 0xff
L_poll_30:
    buffer_load_dword v19, v16, s[8:11], s83 offen sc1
    s_add_u32 s56, s56, 1
    s_waitcnt vmcnt(0)
    v_cmp_ne_u32 vcc, s48, v19
    s_cmp_gt_u32 s56, 200000
    s_cbranch_scc1 L_pollx_31
    s_cbranch_vccnz L_poll_30
L_pollx_31:
    s_mov_b64 exec, -1
    ds_write_b32 v14, v0 offset:96
    s_add_u32 s50, s59, 0
    s_and_b32 s50, s50, 7
    s_lshl_b32 s50, s50, 12
    s_add_u32 s50, s50, s82
    buffer_load_dwordx4 v[128:131], v2, s[8:11], s50 offen offset:0 sc1
    buffer_load_dwordx4 v[132:135], v2, s[8:11], s50 offen offset:1024 sc1
    buffer_load_dwordx4 v[136:139], v2, s[8:11], s50 offen offset:2048 sc1
    buffer_load_dwordx4 v[140:143], v2, s[8:11], s50 offen offset:3072 sc1
    s_add_u32 s50, s59, 1
    s_and_b32 s50, s50, 7
    s_lshl_b32 s50, s50, 12
    s_add_u32 s50, s50, s82
    buffer_load_dwordx4 v[144:147], v2, s[8:11], s50 offen offset:0 sc1
    buffer_load_dwordx4 v[148:151], v2, s[8:11], s50 offen offset:1024 sc1
    buffer_load_dwordx4 v[152:155], v2, s[8:11], s50 offen offset:2048 sc1
    buffer_load_dwordx4 v[156:159], v2, s[8:11], s50 offen offset:3072 sc1
    s_add_u32 s50, s59, 2
    s_and_b32 s50, s50, 7
    s_lshl_b32 s50, s50, 12
    s_add_u32 s50, s50, s82
    buffer_load_dwordx4 v[160:163], v2, s[8:11], s50 offen offset:0 sc1
    buffer_load_dwordx4 v[164:167], v2, s[8:11], s50 offen offset:1024 sc1
    buffer_load_dwordx4 v[168:171], v2, s[8:11], s50 offen offset:2048 sc1
    buffer_load_dwordx4 v[172:175], v2, s[8:11], s50 offen offset:3072 sc1
    s_add_u32 s50, s59, 3
    s_and_b32 s50, s50, 7
    s_lshl_b32 s50, s50, 12
    s_add_u32 s50, s50, s82
    buffer_load_dwordx4 v[176:179], v2, s[8:11], s50 offen offset:0 sc1
    buffer_load_dwordx4 v[180:183], v2, s[8:11], s50 offen offset:1024 sc1
    buffer_load_dwordx4 v[184:187], v2, s[8:11], s50 offen offset:2048 sc1
    buffer_load_dwordx4 v[188:191], v2, s[8:11], s50 offen offset:3072 sc1
    s_add_u32 s50, s59, 4
    s_and_b32 s50, s50, 7
    s_lshl_b32 s50, s50, 12
    s_add_u32 s50, s50, s82
    buffer_load_dwordx4 v[192:195], v2, s[8:11], s50 offen offset:0 sc1
    buffer_load_dwordx4 v[196:199], v2, s[8:11], s50 offen offset:1024 sc1
    buffer_load_dwordx4 v[200:203], v2, s[8:11], s50 offen offset:2048 sc1
    buffer_load_dwordx4 v[204:207], v2, s[8:11], s50 offen offset:3072 sc1
    s_add_u32 s50, s59, 5
    s_and_b32 s50, s50, 7
    s_lshl_b32 s50, s50, 12
    s_add_u32 s50, s50, s82
    buffer_load_dwordx4 v[208:211], v2, s[8:11], s50 offen offset:0 sc1
    buffer_load_dwordx4 v[212:215], v2, s[8:11], s50 offen offset:1024 sc1
    buffer_load_dwordx4 v[216:219], v2, s[8:11], s50 offen offset:2048 sc1
    buffer_load_dwordx4 v[220:223], v2, s[8:11], s50 offen offset:3072 sc1
    s_add_u32 s50, s59, 6
    s_and_b32 s50, s50, 7
    s_lshl_b32 s50, s50, 12
    s_add_u32 s50, s50, s82
    buffer_load_dwordx4 v[224:227], v2, s[8:11], s50 offen offset:0 sc1
    buffer_load_dwordx4 v[228:231], v2, s[8:11], s50 offen offset:1024 sc1
    buffer_load_dwordx4 v[232:235], v2, s[8:11], s50 offen offset:2048 sc1
    buffer_load_dwordx4 v[236:239], v2, s[8:11], s50 offen offset:3072 sc1
    s_add_u32 s50, s59, 7
    s_and_b32 s50, s50, 7
    s_lshl_b32 s50, s50, 12
    s_add_u32 s50, s50, s82
    buffer_load_dwordx4 v[240:243], v2, s[8:11], s50 offen offset:0 sc1
    buffer_load_dwordx4 v[244:247], v2, s[8:11], s50 offen offset:1024 sc1
    buffer_load_dwordx4 v[248:251], v2, s[8:11], s50 offen offset:2048 sc1
    buffer_load_dwordx4 v[252:255], v2, s[8:11], s50 offen offset:3072 sc1
    v_and_b32 v18, 1, v1
    v_lshlrev_b32 v18, 2, v18
    v_add_u32 v18, 148544, v18
    s_mov_b32 s56, 0
L_spin_33:
    ds_read_b32 v15, v18
    s_add_u32 s56, s56, 1
    s_waitcnt lgkmcnt(0)
    v_cmp_gt_u32 vcc, 1, v15
    s_cmp_gt_u32 s56, 2000000
    s_cbranch_scc1 L_spinx_34
    s_cbranch_vccnz L_spin_33
L_spinx_34:
    ds_read_b64_tr_b16 v[48:49], v12 offset:0
    ds_read_b64_tr_b16 v[50:51], v12 offset:256
    ds_read_b64_tr_b16 v[52:53], v12 offset:1024
    ds_read_b64_tr_b16 v[54:55], v12 offset:1280
    ds_read_b64_tr_b16 v[56:57], v12 offset:2048
    ds_read_b64_tr_b16 v[58:59], v12 offset:2304
    ds_read_b64_tr_b16 v[60:61], v12 offset:3072
    ds_read_b64_tr_b16 v[62:63], v12 offset:3328
    s_waitcnt vmcnt(31) lgkmcnt(6)
    v_mfma_f32_32x32x16_bf16 v[64:79], v[48:51], v[128:131], 0
    ds_read_b64_tr_b16 v[48:49], v12 offset:4096
    ds_read_b64_tr_b16 v[50:51], v12 offset:4352
    s_waitcnt vmcnt(30) lgkmcnt(6)
    v_mfma_f32_32x32x16_bf16 v[64:79], v[52:55], v[132:135], v[64:79]
    ds_read_b64_tr_b16 v[52:53], v12 offset:5120
    ds_read_b64_tr_b16 v[54:55], v12 offset:5376
    s_waitcnt vmcnt(29) lgkmcnt(6)
    v_mfma_f32_32x32x16_bf16 v[64:79], v[56:59], v[136:139], v[64:79]
    ds_read_b64_tr_b16 v[56:57], v12 offset:6144
    ds_read_b64_tr_b16 v[58:59], v12 offset:6400
    s_waitcnt vmcnt(28) lgkmcnt(6)
    v_mfma_f32_32x32x16_bf16 v[64:79], v[60:63], v[140:143], v[64:79]
    ds_read_b64_tr_b16 v[60:61], v12 offset:7168
    ds_read_b64_tr_b16 v[62:63], v12 offset:7424
    s_waitcnt vmcnt(27) lgkmcnt(6)
    v_mfma_f32_32x32x16_bf16 v[64:79], v[48:51], v[144:147], v[64:79]
    ds_read_b64_tr_b16 v[48:49], v12 offset:8192
    ds_read_b64_tr_b16 v[50:51], v12 offset:8448
    s_waitcnt vmcnt(26) lgkmcnt(6)
    v_mfma_f32_32x32x16_bf16 v[64:79], v[52:55], v[148:151], v[64:79]
    ds_read_b64_tr_b16 v[52:53], v12 offset:9216
    ds_read_b64_tr_b16 v[54:55], v12 offset:9472
    s_waitcnt vmcnt(25) lgkmcnt(6)
    v_mfma_f32_32x32x16_bf16 v[64:79], v[56:59], v[152:155], v[64:79]
    ds_read_b64_tr_b16 v[56:57], v12 offset:10240
    ds_read_b64_tr_b16 v[58:59], v12 offset:10496
    s_waitcnt vmcnt(24) lgkmcnt(6)
    v_mfma_f32_32x32x16_bf16 v[64:79], v[60:63], v[156:159], v[64:79]
    ds_read_b64_tr_b16 v[60:61], v12 offset:11264
    ds_read_b64_tr_b16 v[62:63], v12 offset:11520
    s_waitcnt vmcnt(23) lgkmcnt(6)
    v_mfma_f32_32x32x16_bf16 v[64:79], v[48:51], v[160:163], v[64:79]
    ds_read_b64_tr_b16 v[48:49], v12 offset:12288
    ds_read_b64_tr_b16 v[50:51], v12 offset:12544
    s_waitcnt vmcnt(22) lgkmcnt(6)
    v_mfma_f32_32x32x16_bf16 v[64:79], v[52:55], v[164:167], v[64:79]
    ds_read_b64_tr_b16 v[52:53], v12 offset:13312
    ds_read_b64_tr_b16 v[54:55], v12 offset:13568
    s_waitcnt vmcnt(21) lgkmcnt(6)
    v_mfma_f32_32x32x16_bf16 v[64:79], v[56:59], v[168:171], v[64:79]
    ds_read_b64_tr_b16 v[56:57], v12 offset:14336
    ds_read_b64_tr_b16 v[58:59], v12 offset:14592
    s_waitcnt vmcnt(20) lgkmcnt(6)
    v_mfma_f32_32x32x16_bf16 v[64:79], v[60:63], v[172:175], v[64:79]
    ds_read_b64_tr_b16 v[60:61], v12 offset:15360
    ds_read_b64_tr_b16 v[62:63], v12 offset:15616
    s_waitcnt vmcnt(19) lgkmcnt(6)
    v_mfma_f32_32x32x16_bf16 v[64:79], v[48:51], v[176:179], v[64:79]
    ds_read_b64_tr_b16 v[48:49], v12 offset:16384
    ds_read_b64_tr_b16 v[50:51], v12 offset:16640
    s_waitcnt vmcnt(18) lgkmcnt(6)
    v_mfma_f32_32x32x16_bf16 v[64:79], v[52:55], v[180:183], v[64:79]
    ds_read_b64_tr_b16 v[52:53], v12 offset:17408
    ds_read_b64_tr_b16 v[54:55], v12 offset:17664
    s_waitcnt vmcnt(17) lgkmcnt(6)
    v_mfma_f32_32x32x16_bf16 v[64:79], v[56:59], v[184:187], v[64:79]
    ds_read_b64_tr_b16 v[56:57], v12 offset:18432
    ds_read_b64_tr_b16 v[58:59], v12 offset:18688
    s_waitcnt vmcnt(16) lgkmcnt(6)
    v_mfma_f32_32x32x16_bf16 v[64:79], v[60:63], v[188:191], v[64:79]
    ds_read_b64_tr_b16 v[60:61], v12 offset:19456
    ds_read_b64_tr_b16 v[62:63], v12 offset:19712
    s_waitcnt vmcnt(15) lgkmcnt(6)
    v_mfma_f32_32x32x16_bf16 v[64:79], v[48:51], v[192:195], v[64:79]
    ds_read_b64_tr_b16 v[48:49], v12 offset:20480
    ds_read_b64_tr_b16 v[50:51], v12 offset:20736
    s_waitcnt vmcnt(14) lgkmcnt(6)
    v_mfma_f32_32x32x16_bf16 v[64:79], v[52:55], v[196:199], v[64:79]
    ds_read_b64_tr_b16 v[52:53], v12 offset:21504
    ds_read_b64_tr_b16 v[54:55], v12 offset:21760
    s_waitcnt vmcnt(13) lgkmcnt(6)
    v_mfma_f32_32x32x16_bf16 v[64:79], v[56:59], v[200:203], v[64:79]
    ds_read_b64_tr_b16 v[56:57], v12 offset:22528
    ds_read_b64_tr_b16 v[58:59], v12 offset:22784
    s_waitcnt vmcnt(12) lgkmcnt(6)
    v_mfma_f32_32x32x16_bf16 v[64:79], v[60:63], v[204:207], v[64:79]
    ds_read_b64_tr_b16 v[60:61], v12 offset:23552
    ds_read_b64_tr_b16 v[62:63], v12 offset:23808
    s_waitcnt vmcnt(11) lgkmcnt(6)
    v_mfma_f32_32x32x16_bf16 v[64:79], v[48:51], v[208:211], v[64:79]
    ds_read_b64_tr_b16 v[48:49], v12 offset:24576
    ds_read_b64_tr_b16 v[50:51], v12 offset:24832
    s_waitcnt vmcnt(10) lgkmcnt(6)
    v_mfma_f32_32x32x16_bf16 v[64:79], v[52:55], v[212:215], v[64:79]
    ds_read_b64_tr_b16 v[52:53], v12 offset:25600
    ds_read_b64_tr_b16 v[54:55], v12 offset:25856
    s_waitcnt vmcnt(9) lgkmcnt(6)
    v_mfma_f32_32x32x16_bf16 v[64:79], v[56:59], v[216:219], v[64:79]
    ds_read_b64_tr_b16 v[56:57], v12 offset:26624
    ds_read_b64_tr_b16 v[58:59], v12 offset:26880
    s_waitcnt vmcnt(8) lgkmcnt(6)
    v_mfma_f32_32x32x16_bf16 v[64:79], v[60:63], v[220:223], v[64:79]
    ds_read_b64_tr_b16 v[60:61], v12 offset:27648
    ds_read_b64_tr_b16 v[62:63], v12 offset:27904
    s_waitcnt vmcnt(7) lgkmcnt(6)
    v_mfma_f32_32x32x16_bf16 v[64:79], v[48:51], v[224:227], v[64:79]
    ds_read_b64_tr_b16 v[48:49], v12 offset:28672
    ds_read_b64_tr_b16 v[50:51], v12 offset:28928
    s_waitcnt vmcnt(6) lgkmcnt(6)
    v_mfma_f32_32x32x16_bf16 v[64:79], v[52:55], v[228:231], v[64:79]
    ds_read_b64_tr_b16 v[52:53], v12 offset:29696
    ds_read_b64_tr_b16 v[54:55], v12 offset:29952
    s_waitcnt vmcnt(5) lgkmcnt(6)
    v_mfma_f32_32x32x16_bf16 v[64:79], v[56:59], v[232:235], v[64:79]
    ds_read_b64_tr_b16 v[56:57], v12 offset:30720
    ds_read_b64_tr_b16 v[58:59], v12 offset:30976
    s_waitcnt vmcnt(4) lgkmcnt(6)
    v_mfma_f32_32x32x16_bf16 v[64:79], v[60:63], v[236:239], v[64:79]
    ds_read_b64_tr_b16 v[60:61], v12 offset:31744
    ds_read_b64_tr_b16 v[62:63], v12 offset:32000
    s_waitcnt vmcnt(3) lgkmcnt(6)
    v_mfma_f32_32x32x16_bf16 v[64:79], v[48:51], v[240:243], v[64:79]
    s_waitcnt vmcnt(2) lgkmcnt(4)
    v_mfma_f32_32x32x16_bf16 v[64:79], v[52:55], v[244:247], v[64:79]
    s_waitcnt vmcnt(1) lgkmcnt(2)
    v_mfma_f32_32x32x16_bf16 v[64:79], v[56:59], v[248:251], v[64:79]
    s_waitcnt vmcnt(0) lgkmcnt(0)
    v_mfma_f32_32x32x16_bf16 v[64:79], v[60:63], v[252:255], v[64:79]
    s_lshl_b32 s50, s44, 11
    s_add_u32 s50, s50, 140288
    v_add_u32 v18, s50, v2
    s_nop 8
    v_pk_mul_f32 v[64:65], v[64:65], s[66:67]
    v_pk_mul_f32 v[66:67], v[66:67], s[66:67]
    v_pk_mul_f32 v[68:69], v[68:69], s[66:67]
    v_pk_mul_f32 v[70:71], v[70:71], s[66:67]
    v_pk_mul_f32 v[72:73], v[72:73], s[66:67]
    v_pk_mul_f32 v[74:75], v[74:75], s[66:67]
    v_pk_mul_f32 v[76:77], v[76:77], s[66:67]
    v_pk_mul_f32 v[78:79], v[78:79], s[66:67]
    v_cvt_pk_bf16_f32 v24, v64, v65
    v_cvt_pk_bf16_f32 v25, v66, v67
    v_cvt_pk_bf16_f32 v26, v68, v69
    v_cvt_pk_bf16_f32 v27, v70, v71
    v_cvt_pk_bf16_f32 v28, v72, v73
    v_cvt_pk_bf16_f32 v29, v74, v75
    v_cvt_pk_bf16_f32 v30, v76, v77
    v_cvt_pk_bf16_f32 v31, v78, v79
    ds_write_b128 v18, v[24:27]
    ds_write_b128 v18, v[28:31] offset:1024
    v_mul_f32 v16, v64, v64
    v_mul_f32 v17, v72, v72
    v_fmac_f32 v16, v65, v65
    v_fmac_f32 v17, v73, v73
    v_fmac_f32 v16, v66, v66
    v_fmac_f32 v17, v74, v74
    v_fmac_f32 v16, v67, v67
    v_fmac_f32 v17, v75, v75
    v_fmac_f32 v16, v68, v68
    v_fmac_f32 v17, v76, v76
    v_fmac_f32 v16, v69, v69
    v_fmac_f32 v17, v77, v77
    v_fmac_f32 v16, v70, v70
    v_fmac_f32 v17, v78, v78
    v_fmac_f32 v16, v71, v71
    v_fmac_f32 v17, v79, v79
    s_nop 1
    v_permlane32_swap_b32 v16, v17
    v_add_f32 v16, v16, v17
    v_and_b32 v16, 0x7fffffff, v16
    s_nop 1
    v_max_u32_dpp v16, v16, v16 quad_perm:[1,0,3,2] row_mask:0xf bank_mask:0xf
    s_nop 1
    v_max_u32_dpp v16, v16, v16 quad_perm:[2,3,0,1] row_mask:0xf bank_mask:0xf
    s_nop 1
    v_max_u32_dpp v16, v16, v16 row_half_mirror row_mask:0xf bank_mask:0xf
    s_nop 1
    v_max_u32_dpp v16, v16, v16 row_mirror row_mask:0xf bank_mask:0xf
    v_mov_b32 v17, v16
    s_nop 1
    v_permlane16_swap_b32 v16, v17
    v_max_u32 v16, v16, v17
    v_mov_b32 v17, v16
    s_nop 1
    v_permlane32_swap_b32 v16, v17
    v_max_u32 v16, v16, v17
    s_waitcnt lgkmcnt(0)
    ds_write_b32 v14, v16 offset:16
    s_mov_b32 s56, 0
L_spin_35:
    ds_read_b32 v15, v14 offset:128
    s_add_u32 s56, s56, 1
    s_waitcnt lgkmcnt(0)
    v_cmp_gt_u32 vcc, 1, v15
    s_cmp_gt_u32 s56, 2000000
    s_cbranch_scc1 L_spinx_36
    s_cbranch_vccnz L_spin_35
L_spinx_36:
    s_add_u32 s50, s59, 0
    s_and_b32 s50, s50, 7
    s_mul_i32 s50, s50, 229376
    s_add_u32 s50, s50, s68
    s_add_u32 m0, s69, 0
    s_add_u32 s51, s50, 27648
    buffer_load_dwordx4 v3, s[24:27], s50 offen lds
    buffer_load_dwordx4 v3, s[24:27], s51 offen offset:1024 lds
    s_add_u32 m0, m0, 2048
    s_nop 0
    buffer_load_dwordx4 v4, s[28:31], s50 offen lds
    buffer_load_dwordx4 v4, s[28:31], s51 offen offset:1024 lds
    s_waitcnt vmcnt(0)
    s_add_u32 s50, s59, 1
    s_and_b32 s50, s50, 7
    s_mul_i32 s50, s50, 229376
    s_add_u32 s50, s50, s68
    s_add_u32 m0, s69, 16384
    s_add_u32 s51, s50, 27648
    buffer_load_dwordx4 v3, s[24:27], s50 offen lds
    buffer_load_dwordx4 v3, s[24:27], s51 offen offset:1024 lds
    s_add_u32 m0, m0, 2048
    s_nop 0
    buffer_load_dwordx4 v4, s[28:31], s50 offen lds
    buffer_load_dwordx4 v4, s[28:31], s51 offen offset:1024 lds
    s_add_u32 s50, s59, 2
    s_and_b32 s50, s50, 7
    s_mul_i32 s50, s50, 229376
    s_add_u32 s50, s50, s68
    s_add_u32 m0, s69, 32768
    s_add_u32 s51, s50, 27648
    buffer_load_dwordx4 v3, s[24:27], s50 offen lds
    buffer_load_dwordx4 v3, s[24:27], s51 offen offset:1024 lds
    s_add_u32 m0, m0, 2048
    s_nop 0
    buffer_load_dwordx4 v4, s[28:31], s50 offen lds
    buffer_load_dwordx4 v4, s[28:31], s51 offen offset:1024 lds
    s_mov_b64 exec, 1
    ds_add_u32 v14, v0
    s_mov_b64 exec, -1
    ds_read_b32 v15, v13
    s_waitcnt lgkmcnt(0)
    s_setprio 2
    s_mov_b32 s56, 0
    v_cmp_gt_u32 vcc, 1, v15
    s_cbranch_vccz L_spinx_38
L_spin_37:
    ds_read_b32 v15, v13
    s_add_u32 s56, s56, 1
    s_waitcnt lgkmcnt(0)
    v_cmp_gt_u32 vcc, 1, v15
    s_cmp_gt_u32 s56, 2000000
    s_cbranch_scc1 L_spinx_38
    s_cbranch_vccnz L_spin_37
L_spinx_38:
    s_setprio 0
    ds_read_b64_tr_b16 v[48:49], v8 offset:0
    ds_read_b64_tr_b16 v[50:51], v8 offset:512
    ds_read_b64_tr_b16 v[52:53], v9 offset:0
    ds_read_b64_tr_b16 v[54:55], v9 offset:512
    ds_read_b64_tr_b16 v[56:57], v10 offset:0
    ds_read_b64_tr_b16 v[58:59], v10 offset:512
    ds_read_b64_tr_b16 v[60:61], v11 offset:0
    ds_read_b64_tr_b16 v[62:63], v11 offset:512
    s_setprio 0
    s_waitcnt lgkmcnt(6)
    v_mfma_f32_32x32x16_bf16 v[64:79], v[48:51], v[128:131], 0
    ds_read_b64_tr_b16 v[48:49], v8 offset:4096
    ds_read_b64_tr_b16 v[50:51], v8 offset:4608
    s_waitcnt lgkmcnt(6)
    v_mfma_f32_32x32x16_bf16 v[80:95], v[52:55], v[128:131], 0
    ds_read_b64_tr_b16 v[52:53], v9 offset:4096
    ds_read_b64_tr_b16 v[54:55], v9 offset:4608
    s_waitcnt vmcnt(4)
    s_mov_b64 exec, 1
    ds_add_u32 v14, v0
    s_mov_b64 exec, -1
    s_waitcnt lgkmcnt(7)
    v_mfma_f32_32x32x16_bf16 v[96:111], v[56:59], v[128:131], 0
    ds_read_b64_tr_b16 v[56:57], v10 offset:4096
    ds_read_b64_tr_b16 v[58:59], v10 offset:4608
    ds_read_b32 v15, v13
    s_waitcnt lgkmcnt(8)
    v_mfma_f32_32x32x16_bf16 v[112:127], v[60:63], v[128:131], 0
    ds_read_b64_tr_b16 v[60:61], v11 offset:4096
    ds_read_b64_tr_b16 v[62:63], v11 offset:4608
    s_waitcnt lgkmcnt(8)
    v_mfma_f32_32x32x16_bf16 v[64:79], v[48:51], v[132:135], v[64:79]
    ds_read_b64_tr_b16 v[48:49], v8 offset:8192
    ds_read_b64_tr_b16 v[50:51], v8 offset:8704
    s_waitcnt lgkmcnt(8)
    v_mfma_f32_32x32x16_bf16 v[80:95], v[52:55], v[132:135], v[80:95]
    ds_read_b64_tr_b16 v[52:53], v9 offset:8192
    ds_read_b64_tr_b16 v[54:55], v9 offset:8704
    s_waitcnt lgkmcnt(6)
    s_setprio 2
    s_mov_b32 s56, 0
    v_cmp_gt_u32 vcc, 2, v15
    s_cbranch_vccz L_spinx_40
L_spin_39:
    ds_read_b32 v15, v13
    s_add_u32 s56, s56, 1
    s_waitcnt lgkmcnt(0)
    v_cmp_gt_u32 vcc, 2, v15
    s_cmp_gt_u32 s56, 2000000
    s_cbranch_scc1 L_spinx_40
    s_cbranch_vccnz L_spin_39
L_spinx_40:
    s_setprio 0
    v_mfma_f32_32x32x16_bf16 v[96:111], v[56:59], v[132:135], v[96:111]
    ds_read_b64_tr_b16 v[56:57], v10 offset:8192
    ds_read_b64_tr_b16 v[58:59], v10 offset:8704
    s_add_u32 s50, s59, 3
    s_and_b32 s50, s50, 7
    s_mul_i32 s50, s50, 229376
    s_add_u32 s50, s50, s68
    s_add_u32 m0, s69, 49152
    s_add_u32 s51, s50, 27648
    buffer_load_dwordx4 v3, s[24:27], s50 offen lds
    s_waitcnt lgkmcnt(6)
    v_mfma_f32_32x32x16_bf16 v[112:127], v[60:63], v[132:135], v[112:127]
    ds_read_b64_tr_b16 v[60:61], v11 offset:8192
    ds_read_b64_tr_b16 v[62:63], v11 offset:8704
    buffer_load_dwordx4 v3, s[24:27], s51 offen offset:1024 lds
    s_add_u32 m0, m0, 2048
    s_waitcnt lgkmcnt(6)
    v_mfma_f32_32x32x16_bf16 v[64:79], v[48:51], v[136:139], v[64:79]
    ds_read_b64_tr_b16 v[48:49], v8 offset:12288
    ds_read_b64_tr_b16 v[50:51], v8 offset:12800
    buffer_load_dwordx4 v4, s[28:31], s50 offen lds
    s_waitcnt lgkmcnt(6)
    v_mfma_f32_32x32x16_bf16 v[80:95], v[52:55], v[136:139], v[80:95]
    ds_read_b64_tr_b16 v[52:53], v9 offset:12288
    ds_read_b64_tr_b16 v[54:55], v9 offset:12800
    buffer_load_dwordx4 v4, s[28:31], s51 offen offset:1024 lds
    s_waitcnt lgkmcnt(6)
    v_mfma_f32_32x32x16_bf16 v[96:111], v[56:59], v[136:139], v[96:111]
    ds_read_b64_tr_b16 v[56:57], v10 offset:12288
    ds_read_b64_tr_b16 v[58:59], v10 offset:12800
    s_waitcnt lgkmcnt(6)
    v_mfma_f32_32x32x16_bf16 v[112:127], v[60:63], v[136:139], v[112:127]
    ds_read_b64_tr_b16 v[60:61], v11 offset:12288
    ds_read_b64_tr_b16 v[62:63], v11 offset:12800
    s_waitcnt lgkmcnt(6)
    v_mfma_f32_32x32x16_bf16 v[64:79], v[48:51], v[140:143], v[64:79]
    ds_read_b64_tr_b16 v[48:49], v8 offset:16384
    ds_read_b64_tr_b16 v[50:51], v8 offset:16896
    s_waitcnt lgkmcnt(6)
    v_mfma_f32_32x32x16_bf16 v[80:95], v[52:55], v[140:143], v[80:95]
    ds_read_b64_tr_b16 v[52:53], v9 offset:16384
    ds_read_b64_tr_b16 v[54:55], v9 offset:16896
    s_waitcnt lgkmcnt(6)
    v_mfma_f32_32x32x16_bf16 v[96:111], v[56:59], v[140:143], v[96:111]
    ds_read_b64_tr_b16 v[56:57], v10 offset:16384
    ds_read_b64_tr_b16 v[58:59], v10 offset:16896
    s_waitcnt lgkmcnt(6)
    v_mfma_f32_32x32x16_bf16 v[112:127], v[60:63], v[140:143], v[112:127]
    ds_read_b64_tr_b16 v[60:61], v11 offset:16384
    ds_read_b64_tr_b16 v[62:63], v11 offset:16896
    s_waitcnt lgkmcnt(6)
    v_mfma_f32_32x32x16_bf16 v[64:79], v[48:51], v[144:147], v[64:79]
    ds_read_b64_tr_b16 v[48:49], v8 offset:20480
    ds_read_b64_tr_b16 v[50:51], v8 offset:20992
    s_waitcnt lgkmcnt(6)
    v_mfma_f32_32x32x16_bf16 v[80:95], v[52:55], v[144:147], v[80:95]
    ds_read_b64_tr_b16 v[52:53], v9 offset:20480
    ds_read_b64_tr_b16 v[54:55], v9 offset:20992
    s_waitcnt vmcnt(4)
    s_mov_b64 exec, 1
    ds_add_u32 v14, v0
    s_mov_b64 exec, -1
    s_waitcnt lgkmcnt(7)
    v_mfma_f32_32x32x16_bf16 v[96:111], v[56:59], v[144:147], v[96:111]
    ds_read_b64_tr_b16 v[56:57], v10 offset:20480
    ds_read_b64_tr_b16 v[58:59], v10 offset:20992
    ds_read_b32 v15, v13
    s_waitcnt lgkmcnt(8)
    v_mfma_f32_32x32x16_bf16 v[112:127], v[60:63], v[144:147], v[112:127]
    ds_read_b64_tr_b16 v[60:61], v11 offset:20480
    ds_read_b64_tr_b16 v[62:63], v11 offset:20992
    s_waitcnt lgkmcnt(8)
    v_mfma_f32_32x32x16_bf16 v[64:79], v[48:51], v[148:151], v[64:79]
    ds_read_b64_tr_b16 v[48:49], v8 offset:24576
    ds_read_b64_tr_b16 v[50:51], v8 offset:25088
    s_waitcnt lgkmcnt(8)
    v_mfma_f32_32x32x16_bf16 v[80:95], v[52:55], v[148:151], v[80:95]
    ds_read_b64_tr_b16 v[52:53], v9 offset:24576
    ds_read_b64_tr_b16 v[54:55], v9 offset:25088
    s_waitcnt lgkmcnt(6)
    s_setprio 2
    s_mov_b32 s56, 0
    v_cmp_gt_u32 vcc, 3, v15
    s_cbranch_vccz L_spinx_42
L_spin_41:
    ds_read_b32 v15, v13
    s_add_u32 s56, s56, 1
    s_waitcnt lgkmcnt(0)
    v_cmp_gt_u32 vcc, 3, v15
    s_cmp_gt_u32 s56, 2000000
    s_cbranch_scc1 L_spinx_42
    s_cbranch_vccnz L_spin_41
L_spinx_42:
    s_setprio 0
    v_mfma_f32_32x32x16_bf16 v[96:111], v[56:59], v[148:151], v[96:111]
    ds_read_b64_tr_b16 v[56:57], v10 offset:24576
    ds_read_b64_tr_b16 v[58:59], v10 offset:25088
    s_add_u32 s50, s59, 4
    s_and_b32 s50, s50, 7
    s_mul_i32 s50, s50, 229376
    s_add_u32 s50, s50, s68
    s_add_u32 m0, s69, 0
    s_add_u32 s51, s50, 27648
    buffer_load_dwordx4 v3, s[24:27], s50 offen lds
    s_waitcnt lgkmcnt(6)
    v_mfma_f32_32x32x16_bf16 v[112:127], v[60:63], v[148:151], v[112:127]
    ds_read_b64_tr_b16 v[60:61], v11 offset:24576
    ds_read_b64_tr_b16 v[62:63], v11 offset:25088
    buffer_load_dwordx4 v3, s[24:27], s51 offen offset:1024 lds
    s_add_u32 m0, m0, 2048
    s_waitcnt lgkmcnt(6)
    v_mfma_f32_32x32x16_bf16 v[64:79], v[48:51], v[152:155], v[64:79]
    ds_read_b64_tr_b16 v[48:49], v8 offset:28672
    ds_read_b64_tr_b16 v[50:51], v8 offset:29184
    buffer_load_dwordx4 v4, s[28:31], s50 offen lds
    s_waitcnt lgkmcnt(6)
    v_mfma_f32_32x32x16_bf16 v[80:95], v[52:55], v[152:155], v[80:95]
    ds_read_b64_tr_b16 v[52:53], v9 offset:28672
    ds_read_b64_tr_b16 v[54:55], v9 offset:29184
    buffer_load_dwordx4 v4, s[28:31], s51 offen offset:1024 lds
    s_waitcnt lgkmcnt(6)
    v_mfma_f32_32x32x16_bf16 v[96:111], v[56:59], v[152:155], v[96:111]
    ds_read_b64_tr_b16 v[56:57], v10 offset:28672
    ds_read_b64_tr_b16 v[58:59], v10 offset:29184
    s_waitcnt lgkmcnt(6)
    v_mfma_f32_32x32x16_bf16 v[112:127], v[60:63], v[152:155], v[112:127]
    ds_read_b64_tr_b16 v[60:61], v11 offset:28672
    ds_read_b64_tr_b16 v[62:63], v11 offset:29184
    s_waitcnt lgkmcnt(6)
    v_mfma_f32_32x32x16_bf16 v[64:79], v[48:51], v[156:159], v[64:79]
    ds_read_b64_tr_b16 v[48:49], v8 offset:32768
    ds_read_b64_tr_b16 v[50:51], v8 offset:33280
    s_waitcnt lgkmcnt(6)
    v_mfma_f32_32x32x16_bf16 v[80:95], v[52:55], v[156:159], v[80:95]
    ds_read_b64_tr_b16 v[52:53], v9 offset:32768
    ds_read_b64_tr_b16 v[54:55], v9 offset:33280
    s_waitcnt lgkmcnt(6)
    v_mfma_f32_32x32x16_bf16 v[96:111], v[56:59], v[156:159], v[96:111]
    ds_read_b64_tr_b16 v[56:57], v10 offset:32768
    ds_read_b64_tr_b16 v[58:59], v10 offset:33280
    s_waitcnt lgkmcnt(6)
    v_mfma_f32_32x32x16_bf16 v[112:127], v[60:63], v[156:159], v[112:127]
    ds_read_b64_tr_b16 v[60:61], v11 offset:32768
    ds_read_b64_tr_b16 v[62:63], v11 offset:33280
    s_waitcnt lgkmcnt(6)
    v_mfma_f32_32x32x16_bf16 v[64:79], v[48:51], v[160:163], v[64:79]
    ds_read_b64_tr_b16 v[48:49], v8 offset:36864
    ds_read_b64_tr_b16 v[50:51], v8 offset:37376
    s_waitcnt lgkmcnt(6)
    v_mfma_f32_32x32x16_bf16 v[80:95], v[52:55], v[160:163], v[80:95]
    ds_read_b64_tr_b16 v[52:53], v9 offset:36864
    ds_read_b64_tr_b16 v[54:55], v9 offset:37376
    s_waitcnt vmcnt(4)
    s_mov_b64 exec, 1
    ds_add_u32 v14, v0
    s_mov_b64 exec, -1
    s_waitcnt lgkmcnt(7)
    v_mfma_f32_32x32x16_bf16 v[96:111], v[56:59], v[160:163], v[96:111]
    ds_read_b64_tr_b16 v[56:57], v10 offset:36864
    ds_read_b64_tr_b16 v[58:59], v10 offset:37376
    ds_read_b32 v15, v13
    s_waitcnt lgkmcnt(8)
    v_mfma_f32_32x32x16_bf16 v[112:127], v[60:63], v[160:163], v[112:127]
    ds_read_b64_tr_b16 v[60:61], v11 offset:36864
    ds_read_b64_tr_b16 v[62:63], v11 offset:37376
    s_waitcnt lgkmcnt(8)
    v_mfma_f32_32x32x16_bf16 v[64:79], v[48:51], v[164:167], v[64:79]
    ds_read_b64_tr_b16 v[48:49], v8 offset:40960
    ds_read_b64_tr_b16 v[50:51], v8 offset:41472
    s_waitcnt lgkmcnt(8)
    v_mfma_f32_32x32x16_bf16 v[80:95], v[52:55], v[164:167], v[80:95]
    ds_read_b64_tr_b16 v[52:53], v9 offset:40960
    ds_read_b64_tr_b16 v[54:55], v9 offset:41472
    s_waitcnt lgkmcnt(6)
    s_setprio 2
    s_mov_b32 s56, 0
    v_cmp_gt_u32 vcc, 4, v15
    s_cbranch_vccz L_spinx_44
L_spin_43:
    ds_read_b32 v15, v13
    s_add_u32 s56, s56, 1
    s_waitcnt lgkmcnt(0)
    v_cmp_gt_u32 vcc, 4, v15
    s_cmp_gt_u32 s56, 2000000
    s_cbranch_scc1 L_spinx_44
    s_cbranch_vccnz L_spin_43
L_spinx_44:
    s_setprio 0
    v_mfma_f32_32x32x16_bf16 v[96:111], v[56:59], v[164:167], v[96:111]
    ds_read_b64_tr_b16 v[56:57], v10 offset:40960
    ds_read_b64_tr_b16 v[58:59], v10 offset:41472
    s_add_u32 s50, s59, 5
    s_and_b32 s50, s50, 7
    s_mul_i32 s50, s50, 229376
    s_add_u32 s50, s50, s68
    s_add_u32 m0, s69, 16384
    s_add_u32 s51, s50, 27648
    buffer_load_dwordx4 v3, s[24:27], s50 offen lds
    s_waitcnt lgkmcnt(6)
    v_mfma_f32_32x32x16_bf16 v[112:127], v[60:63], v[164:167], v[112:127]
    ds_read_b64_tr_b16 v[60:61], v11 offset:40960
    ds_read_b64_tr_b16 v[62:63], v11 offset:41472
    buffer_load_dwordx4 v3, s[24:27], s51 offen offset:1024 lds
    s_add_u32 m0, m0, 2048
    s_waitcnt lgkmcnt(6)
    v_mfma_f32_32x32x16_bf16 v[64:79], v[48:51], v[168:171], v[64:79]
    ds_read_b64_tr_b16 v[48:49], v8 offset:45056
    ds_read_b64_tr_b16 v[50:51], v8 offset:45568
    buffer_load_dwordx4 v4, s[28:31], s50 offen lds
    s_waitcnt lgkmcnt(6)
    v_mfma_f32_32x32x16_bf16 v[80:95], v[52:55], v[168:171], v[80:95]
    ds_read_b64_tr_b16 v[52:53], v9 offset:45056
    ds_read_b64_tr_b16 v[54:55], v9 offset:45568
    buffer_load_dwordx4 v4, s[28:31], s51 offen offset:1024 lds
    s_waitcnt lgkmcnt(6)
    v_mfma_f32_32x32x16_bf16 v[96:111], v[56:59], v[168:171], v[96:111]
    ds_read_b64_tr_b16 v[56:57], v10 offset:45056
    ds_read_b64_tr_b16 v[58:59], v10 offset:45568
    s_waitcnt lgkmcnt(6)
    v_mfma_f32_32x32x16_bf16 v[112:127], v[60:63], v[168:171], v[112:127]
    ds_read_b64_tr_b16 v[60:61], v11 offset:45056
    ds_read_b64_tr_b16 v[62:63], v11 offset:45568
    s_waitcnt lgkmcnt(6)
    v_mfma_f32_32x32x16_bf16 v[64:79], v[48:51], v[172:175], v[64:79]
    ds_read_b64_tr_b16 v[48:49], v8 offset:49152
    ds_read_b64_tr_b16 v[50:51], v8 offset:49664
    s_waitcnt lgkmcnt(6)
    v_mfma_f32_32x32x16_bf16 v[80:95], v[52:55], v[172:175], v[80:95]
    ds_read_b64_tr_b16 v[52:53], v9 offset:49152
    ds_read_b64_tr_b16 v[54:55], v9 offset:49664
    s_waitcnt lgkmcnt(6)
    v_mfma_f32_32x32x16_bf16 v[96:111], v[56:59], v[172:175], v[96:111]
    ds_read_b64_tr_b16 v[56:57], v10 offset:49152
    ds_read_b64_tr_b16 v[58:59], v10 offset:49664
    s_waitcnt lgkmcnt(6)
    v_mfma_f32_32x32x16_bf16 v[112:127], v[60:63], v[172:175], v[112:127]
    ds_read_b64_tr_b16 v[60:61], v11 offset:49152
    ds_read_b64_tr_b16 v[62:63], v11 offset:49664
    s_waitcnt lgkmcnt(6)
    v_mfma_f32_32x32x16_bf16 v[64:79], v[48:51], v[176:179], v[64:79]
    ds_read_b64_tr_b16 v[48:49], v8 offset:53248
    ds_read_b64_tr_b16 v[50:51], v8 offset:53760
    s_waitcnt lgkmcnt(6)
    v_mfma_f32_32x32x16_bf16 v[80:95], v[52:55], v[176:179], v[80:95]
    ds_read_b64_tr_b16 v[52:53], v9 offset:53248
    ds_read_b64_tr_b16 v[54:55], v9 offset:53760
    s_waitcnt vmcnt(4)
    s_mov_b64 exec, 1
    ds_add_u32 v14, v0
    s_mov_b64 exec, -1
    s_waitcnt lgkmcnt(7)
    v_mfma_f32_32x32x16_bf16 v[96:111], v[56:59], v[176:179], v[96:111]
    ds_read_b64_tr_b16 v[56:57], v10 offset:53248
    ds_read_b64_tr_b16 v[58:59], v10 offset:53760
    ds_read_b32 v15, v13
    s_waitcnt lgkmcnt(8)
    v_mfma_f32_32x32x16_bf16 v[112:127], v[60:63], v[176:179], v[112:127]
    ds_read_b64_tr_b16 v[60:61], v11 offset:53248
    ds_read_b64_tr_b16 v[62:63], v11 offset:53760
    s_waitcnt lgkmcnt(8)
    v_mfma_f32_32x32x16_bf16 v[64:79], v[48:51], v[180:183], v[64:79]
    ds_read_b64_tr_b16 v[48:49], v8 offset:57344
    ds_read_b64_tr_b16 v[50:51], v8 offset:57856
    s_waitcnt lgkmcnt(8)
    v_mfma_f32_32x32x16_bf16 v[80:95], v[52:55], v[180:183], v[80:95]
    ds_read_b64_tr_b16 v[52:53], v9 offset:57344
    ds_read_b64_tr_b16 v[54:55], v9 offset:57856
    s_waitcnt lgkmcnt(6)
    s_setprio 2
    s_mov_b32 s56, 0
    v_cmp_gt_u32 vcc, 5, v15
    s_cbranch_vccz L_spinx_46
L_spin_45:
    ds_read_b32 v15, v13
    s_add_u32 s56, s56, 1
    s_waitcnt lgkmcnt(0)
    v_cmp_gt_u32 vcc, 5, v15
    s_cmp_gt_u32 s56, 2000000
    s_cbranch_scc1 L_spinx_46
    s_cbranch_vccnz L_spin_45
L_spinx_46:
    s_setprio 0
    v_mfma_f32_32x32x16_bf16 v[96:111], v[56:59], v[180:183], v[96:111]
    ds_read_b64_tr_b16 v[56:57], v10 offset:57344
    ds_read_b64_tr_b16 v[58:59], v10 offset:57856
    s_add_u32 s50, s59, 6
    s_and_b32 s50, s50, 7
    s_mul_i32 s50, s50, 229376
    s_add_u32 s50, s50, s68
    s_add_u32 m0, s69, 32768
    s_add_u32 s51, s50, 27648
    buffer_load_dwordx4 v3, s[24:27], s50 offen lds
    s_waitcnt lgkmcnt(6)
    v_mfma_f32_32x32x16_bf16 v[112:127], v[60:63], v[180:183], v[112:127]
    ds_read_b64_tr_b16 v[60:61], v11 offset:57344
    ds_read_b64_tr_b16 v[62:63], v11 offset:57856
    buffer_load_dwordx4 v3, s[24:27], s51 offen offset:1024 lds
    s_add_u32 m0, m0, 2048
    s_waitcnt lgkmcnt(6)
    v_mfma_f32_32x32x16_bf16 v[64:79], v[48:51], v[184:187], v[64:79]
    ds_read_b64_tr_b16 v[48:49], v8 offset:61440
    ds_read_b64_tr_b16 v[50:51], v8 offset:61952
    buffer_load_dwordx4 v4, s[28:31], s50 offen lds
    s_waitcnt lgkmcnt(6)
    v_mfma_f32_32x32x16_bf16 v[80:95], v[52:55], v[184:187], v[80:95]
    ds_read_b64_tr_b16 v[52:53], v9 offset:61440
    ds_read_b64_tr_b16 v[54:55], v9 offset:61952
    buffer_load_dwordx4 v4, s[28:31], s51 offen offset:1024 lds
    s_waitcnt lgkmcnt(6)
    v_mfma_f32_32x32x16_bf16 v[96:111], v[56:59], v[184:187], v[96:111]
    ds_read_b64_tr_b16 v[56:57], v10 offset:61440
    ds_read_b64_tr_b16 v[58:59], v10 offset:61952
    s_waitcnt lgkmcnt(6)
    v_mfma_f32_32x32x16_bf16 v[112:127], v[60:63], v[184:187], v[112:127]
    ds_read_b64_tr_b16 v[60:61], v11 offset:61440
    ds_read_b64_tr_b16 v[62:63], v11 offset:61952
    s_waitcnt lgkmcnt(6)
    v_mfma_f32_32x32x16_bf16 v[64:79], v[48:51], v[188:191], v[64:79]
    ds_read_b64_tr_b16 v[48:49], v8 offset:0
    ds_read_b64_tr_b16 v[50:51], v8 offset:512
    s_waitcnt lgkmcnt(6)
    v_mfma_f32_32x32x16_bf16 v[80:95], v[52:55], v[188:191], v[80:95]
    ds_read_b64_tr_b16 v[52:53], v9 offset:0
    ds_read_b64_tr_b16 v[54:55], v9 offset:512
    s_waitcnt lgkmcnt(6)
    v_mfma_f32_32x32x16_bf16 v[96:111], v[56:59], v[188:191], v[96:111]
    ds_read_b64_tr_b16 v[56:57], v10 offset:0
    ds_read_b64_tr_b16 v[58:59], v10 offset:512
    s_waitcnt lgkmcnt(6)
    v_mfma_f32_32x32x16_bf16 v[112:127], v[60:63], v[188:191], v[112:127]
    ds_read_b64_tr_b16 v[60:61], v11 offset:0
    ds_read_b64_tr_b16 v[62:63], v11 offset:512
    s_waitcnt lgkmcnt(6)
    v_mfma_f32_32x32x16_bf16 v[64:79], v[48:51], v[192:195], v[64:79]
    ds_read_b64_tr_b16 v[48:49], v8 offset:4096
    ds_read_b64_tr_b16 v[50:51], v8 offset:4608
    s_waitcnt lgkmcnt(6)
    v_mfma_f32_32x32x16_bf16 v[80:95], v[52:55], v[192:195], v[80:95]
    ds_read_b64_tr_b16 v[52:53], v9 offset:4096
    ds_read_b64_tr_b16 v[54:55], v9 offset:4608
    s_waitcnt vmcnt(4)
    s_mov_b64 exec, 1
    ds_add_u32 v14, v0
    s_mov_b64 exec, -1
    s_waitcnt lgkmcnt(7)
    v_mfma_f32_32x32x16_bf16 v[96:111], v[56:59], v[192:195], v[96:111]
    ds_read_b64_tr_b16 v[56:57], v10 offset:4096
    ds_read_b64_tr_b16 v[58:59], v10 offset:4608
    ds_read_b32 v15, v13
    s_waitcnt lgkmcnt(8)
    v_mfma_f32_32x32x16_bf16 v[112:127], v[60:63], v[192:195], v[112:127]
    ds_read_b64_tr_b16 v[60:61], v11 offset:4096
    ds_read_b64_tr_b16 v[62:63], v11 offset:4608
    s_waitcnt lgkmcnt(8)
    v_mfma_f32_32x32x16_bf16 v[64:79], v[48:51], v[196:199], v[64:79]
    ds_read_b64_tr_b16 v[48:49], v8 offset:8192
    ds_read_b64_tr_b16 v[50:51], v8 offset:8704
    s_waitcnt lgkmcnt(8)
    v_mfma_f32_32x32x16_bf16 v[80:95], v[52:55], v[196:199], v[80:95]
    ds_read_b64_tr_b16 v[52:53], v9 offset:8192
    ds_read_b64_tr_b16 v[54:55], v9 offset:8704
    s_waitcnt lgkmcnt(6)
    s_setprio 2
    s_mov_b32 s56, 0
    v_cmp_gt_u32 vcc, 6, v15
    s_cbranch_vccz L_spinx_48
L_spin_47:
    ds_read_b32 v15, v13
    s_add_u32 s56, s56, 1
    s_waitcnt lgkmcnt(0)
    v_cmp_gt_u32 vcc, 6, v15
    s_cmp_gt_u32 s56, 2000000
    s_cbranch_scc1 L_spinx_48
    s_cbranch_vccnz L_spin_47
L_spinx_48:
    s_setprio 0
    v_mfma_f32_32x32x16_bf16 v[96:111], v[56:59], v[196:199], v[96:111]
    ds_read_b64_tr_b16 v[56:57], v10 offset:8192
    ds_read_b64_tr_b16 v[58:59], v10 offset:8704
    s_add_u32 s50, s59, 7
    s_and_b32 s50, s50, 7
    s_mul_i32 s50, s50, 229376
    s_add_u32 s50, s50, s68
    s_add_u32 m0, s69, 49152
    s_add_u32 s51, s50, 27648
    buffer_load_dwordx4 v3, s[24:27], s50 offen lds
    s_waitcnt lgkmcnt(6)
    v_mfma_f32_32x32x16_bf16 v[112:127], v[60:63], v[196:199], v[112:127]
    ds_read_b64_tr_b16 v[60:61], v11 offset:8192
    ds_read_b64_tr_b16 v[62:63], v11 offset:8704
    buffer_load_dwordx4 v3, s[24:27], s51 offen offset:1024 lds
    s_add_u32 m0, m0, 2048
    s_waitcnt lgkmcnt(6)
    v_mfma_f32_32x32x16_bf16 v[64:79], v[48:51], v[200:203], v[64:79]
    ds_read_b64_tr_b16 v[48:49], v8 offset:12288
    ds_read_b64_tr_b16 v[50:51], v8 offset:12800
    buffer_load_dwordx4 v4, s[28:31], s50 offen lds
    s_waitcnt lgkmcnt(6)
    v_mfma_f32_32x32x16_bf16 v[80:95], v[52:55], v[200:203], v[80:95]
    ds_read_b64_tr_b16 v[52:53], v9 offset:12288
    ds_read_b64_tr_b16 v[54:55], v9 offset:12800
    buffer_load_dwordx4 v4, s[28:31], s51 offen offset:1024 lds
    s_waitcnt lgkmcnt(6)
    v_mfma_f32_32x32x16_bf16 v[96:111], v[56:59], v[200:203], v[96:111]
    ds_read_b64_tr_b16 v[56:57], v10 offset:12288
    ds_read_b64_tr_b16 v[58:59], v10 offset:12800
    s_waitcnt lgkmcnt(6)
    v_mfma_f32_32x32x16_bf16 v[112:127], v[60:63], v[200:203], v[112:127]
    ds_read_b64_tr_b16 v[60:61], v11 offset:12288
    ds_read_b64_tr_b16 v[62:63], v11 offset:12800
    s_waitcnt lgkmcnt(6)
    v_mfma_f32_32x32x16_bf16 v[64:79], v[48:51], v[204:207], v[64:79]
    ds_read_b64_tr_b16 v[48:49], v8 offset:16384
    ds_read_b64_tr_b16 v[50:51], v8 offset:16896
    s_waitcnt lgkmcnt(6)
    v_mfma_f32_32x32x16_bf16 v[80:95], v[52:55], v[204:207], v[80:95]
    ds_read_b64_tr_b16 v[52:53], v9 offset:16384
    ds_read_b64_tr_b16 v[54:55], v9 offset:16896
    s_waitcnt lgkmcnt(6)
    v_mfma_f32_32x32x16_bf16 v[96:111], v[56:59], v[204:207], v[96:111]
    ds_read_b64_tr_b16 v[56:57], v10 offset:16384
    ds_read_b64_tr_b16 v[58:59], v10 offset:16896
    s_waitcnt lgkmcnt(6)
    v_mfma_f32_32x32x16_bf16 v[112:127], v[60:63], v[204:207], v[112:127]
    ds_read_b64_tr_b16 v[60:61], v11 offset:16384
    ds_read_b64_tr_b16 v[62:63], v11 offset:16896
    s_waitcnt lgkmcnt(6)
    v_mfma_f32_32x32x16_bf16 v[64:79], v[48:51], v[208:211], v[64:79]
    ds_read_b64_tr_b16 v[48:49], v8 offset:20480
    ds_read_b64_tr_b16 v[50:51], v8 offset:20992
    s_waitcnt lgkmcnt(6)
    v_mfma_f32_32x32x16_bf16 v[80:95], v[52:55], v[208:211], v[80:95]
    ds_read_b64_tr_b16 v[52:53], v9 offset:20480
    ds_read_b64_tr_b16 v[54:55], v9 offset:20992
    s_waitcnt vmcnt(4)
    s_mov_b64 exec, 1
    ds_add_u32 v14, v0
    s_mov_b64 exec, -1
    s_waitcnt lgkmcnt(7)
    v_mfma_f32_32x32x16_bf16 v[96:111], v[56:59], v[208:211], v[96:111]
    ds_read_b64_tr_b16 v[56:57], v10 offset:20480
    ds_read_b64_tr_b16 v[58:59], v10 offset:20992
    ds_read_b32 v15, v13
    s_waitcnt lgkmcnt(8)
    v_mfma_f32_32x32x16_bf16 v[112:127], v[60:63], v[208:211], v[112:127]
    ds_read_b64_tr_b16 v[60:61], v11 offset:20480
    ds_read_b64_tr_b16 v[62:63], v11 offset:20992
    s_waitcnt lgkmcnt(8)
    v_mfma_f32_32x32x16_bf16 v[64:79], v[48:51], v[212:215], v[64:79]
    ds_read_b64_tr_b16 v[48:49], v8 offset:24576
    ds_read_b64_tr_b16 v[50:51], v8 offset:25088
    s_waitcnt lgkmcnt(8)
    v_mfma_f32_32x32x16_bf16 v[80:95], v[52:55], v[212:215], v[80:95]
    ds_read_b64_tr_b16 v[52:53], v9 offset:24576
    ds_read_b64_tr_b16 v[54:55], v9 offset:25088
    s_waitcnt lgkmcnt(6)
    s_setprio 2
    s_mov_b32 s56, 0
    v_cmp_gt_u32 vcc, 7, v15
    s_cbranch_vccz L_spinx_50
L_spin_49:
    ds_read_b32 v15, v13
    s_add_u32 s56, s56, 1
    s_waitcnt lgkmcnt(0)
    v_cmp_gt_u32 vcc, 7, v15
    s_cmp_gt_u32 s56, 2000000
    s_cbranch_scc1 L_spinx_50
    s_cbranch_vccnz L_spin_49
L_spinx_50:
    s_setprio 0
    v_mfma_f32_32x32x16_bf16 v[96:111], v[56:59], v[212:215], v[96:111]
    ds_read_b64_tr_b16 v[56:57], v10 offset:24576
    ds_read_b64_tr_b16 v[58:59], v10 offset:25088
    s_add_u32 s50, s59, 0
    s_and_b32 s50, s50, 7
    s_mul_i32 s50, s50, 229376
    s_add_u32 s50, s50, s68
    s_add_u32 m0, s69, 0
    s_add_u32 s50, s50, s78
    s_add_u32 s51, s50, 27648
    buffer_load_dwordx4 v5, s[24:27], s50 offen lds
    s_waitcnt lgkmcnt(6)
    v_mfma_f32_32x32x16_bf16 v[112:127], v[60:63], v[212:215], v[112:127]
    ds_read_b64_tr_b16 v[60:61], v11 offset:24576
    ds_read_b64_tr_b16 v[62:63], v11 offset:25088
    buffer_load_dwordx4 v5, s[24:27], s51 offen offset:1024 lds
    s_add_u32 m0, m0, 2048
    s_waitcnt lgkmcnt(6)
    v_mfma_f32_32x32x16_bf16 v[64:79], v[48:51], v[216:219], v[64:79]
    ds_read_b64_tr_b16 v[48:49], v8 offset:28672
    ds_read_b64_tr_b16 v[50:51], v8 offset:29184
    buffer_load_dwordx4 v6, s[28:31], s50 offen lds
    s_waitcnt lgkmcnt(6)
    v_mfma_f32_32x32x16_bf16 v[80:95], v[52:55], v[216:219], v[80:95]
    ds_read_b64_tr_b16 v[52:53], v9 offset:28672
    ds_read_b64_tr_b16 v[54:55], v9 offset:29184
    buffer_load_dwordx4 v6, s[28:31], s51 offen offset:1024 lds
    s_waitcnt lgkmcnt(6)
    v_mfma_f32_32x32x16_bf16 v[96:111], v[56:59], v[216:219], v[96:111]
    ds_read_b64_tr_b16 v[56:57], v10 offset:28672
    ds_read_b64_tr_b16 v[58:59], v10 offset:29184
    s_waitcnt lgkmcnt(6)
    v_mfma_f32_32x32x16_bf16 v[112:127], v[60:63], v[216:219], v[112:127]
    ds_read_b64_tr_b16 v[60:61], v11 offset:28672
    ds_read_b64_tr_b16 v[62:63], v11 offset:29184
    s_waitcnt lgkmcnt(6)
    v_mfma_f32_32x32x16_bf16 v[64:79], v[48:51], v[220:223], v[64:79]
    ds_read_b64_tr_b16 v[48:49], v8 offset:32768
    ds_read_b64_tr_b16 v[50:51], v8 offset:33280
    s_waitcnt lgkmcnt(6)
    v_mfma_f32_32x32x16_bf16 v[80:95], v[52:55], v[220:223], v[80:95]
    ds_read_b64_tr_b16 v[52:53], v9 offset:32768
    ds_read_b64_tr_b16 v[54:55], v9 offset:33280
    s_waitcnt lgkmcnt(6)
    v_mfma_f32_32x32x16_bf16 v[96:111], v[56:59], v[220:223], v[96:111]
    ds_read_b64_tr_b16 v[56:57], v10 offset:32768
    ds_read_b64_tr_b16 v[58:59], v10 offset:33280
    s_waitcnt lgkmcnt(6)
    v_mfma_f32_32x32x16_bf16 v[112:127], v[60:63], v[220:223], v[112:127]
    ds_read_b64_tr_b16 v[60:61], v11 offset:32768
    ds_read_b64_tr_b16 v[62:63], v11 offset:33280
    s_waitcnt lgkmcnt(6)
    v_mfma_f32_32x32x16_bf16 v[64:79], v[48:51], v[224:227], v[64:79]
    ds_read_b64_tr_b16 v[48:49], v8 offset:36864
    ds_read_b64_tr_b16 v[50:51], v8 offset:37376
    s_waitcnt lgkmcnt(6)
    v_mfma_f32_32x32x16_bf16 v[80:95], v[52:55], v[224:227], v[80:95]
    ds_read_b64_tr_b16 v[52:53], v9 offset:36864
    ds_read_b64_tr_b16 v[54:55], v9 offset:37376
    s_waitcnt vmcnt(4)
    s_mov_b64 exec, 1
    ds_add_u32 v14, v0
    s_mov_b64 exec, -1
    s_waitcnt lgkmcnt(7)
    v_mfma_f32_32x32x16_bf16 v[96:111], v[56:59], v[224:227], v[96:111]
    ds_read_b64_tr_b16 v[56:57], v10 offset:36864
    ds_read_b64_tr_b16 v[58:59], v10 offset:37376
    ds_read_b32 v15, v13
    s_waitcnt lgkmcnt(8)
    v_mfma_f32_32x32x16_bf16 v[112:127], v[60:63], v[224:227], v[112:127]
    ds_read_b64_tr_b16 v[60:61], v11 offset:36864
    ds_read_b64_tr_b16 v[62:63], v11 offset:37376
    s_waitcnt lgkmcnt(8)
    v_mfma_f32_32x32x16_bf16 v[64:79], v[48:51], v[228:231], v[64:79]
    ds_read_b64_tr_b16 v[48:49], v8 offset:40960
    ds_read_b64_tr_b16 v[50:51], v8 offset:41472
    s_waitcnt lgkmcnt(8)
    v_mfma_f32_32x32x16_bf16 v[80:95], v[52:55], v[228:231], v[80:95]
    ds_read_b64_tr_b16 v[52:53], v9 offset:40960
    ds_read_b64_tr_b16 v[54:55], v9 offset:41472
    s_waitcnt lgkmcnt(6)
    s_setprio 2
    s_mov_b32 s56, 0
    v_cmp_gt_u32 vcc, 8, v15
    s_cbranch_vccz L_spinx_52
L_spin_51:
    ds_read_b32 v15, v13
    s_add_u32 s56, s56, 1
    s_waitcnt lgkmcnt(0)
    v_cmp_gt_u32 vcc, 8, v15
    s_cmp_gt_u32 s56, 2000000
    s_cbranch_scc1 L_spinx_52
    s_cbranch_vccnz L_spin_51
L_spinx_52:
    s_setprio 0
    v_mfma_f32_32x32x16_bf16 v[96:111], v[56:59], v[228:231], v[96:111]
    ds_read_b64_tr_b16 v[56:57], v10 offset:40960
    ds_read_b64_tr_b16 v[58:59], v10 offset:41472
    s_add_u32 s50, s59, 1
    s_and_b32 s50, s50, 7
    s_mul_i32 s50, s50, 229376
    s_add_u32 s50, s50, s68
    s_add_u32 m0, s69, 16384
    s_add_u32 s50, s50, s78
    s_add_u32 s51, s50, 27648
    buffer_load_dwordx4 v5, s[24:27], s50 offen lds
    s_waitcnt lgkmcnt(6)
    v_mfma_f32_32x32x16_bf16 v[112:127], v[60:63], v[228:231], v[112:127]
    ds_read_b64_tr_b16 v[60:61], v11 offset:40960
    ds_read_b64_tr_b16 v[62:63], v11 offset:41472
    buffer_load_dwordx4 v5, s[24:27], s51 offen offset:1024 lds
    s_add_u32 m0, m0, 2048
    s_waitcnt lgkmcnt(6)
    v_mfma_f32_32x32x16_bf16 v[64:79], v[48:51], v[232:235], v[64:79]
    ds_read_b64_tr_b16 v[48:49], v8 offset:45056
    ds_read_b64_tr_b16 v[50:51], v8 offset:45568
    buffer_load_dwordx4 v6, s[28:31], s50 offen lds
    s_waitcnt lgkmcnt(6)
    v_mfma_f32_32x32x16_bf16 v[80:95], v[52:55], v[232:235], v[80:95]
    ds_read_b64_tr_b16 v[52:53], v9 offset:45056
    ds_read_b64_tr_b16 v[54:55], v9 offset:45568
    buffer_load_dwordx4 v6, s[28:31], s51 offen offset:1024 lds
    s_waitcnt lgkmcnt(6)
    v_mfma_f32_32x32x16_bf16 v[96:111], v[56:59], v[232:235], v[96:111]
    ds_read_b64_tr_b16 v[56:57], v10 offset:45056
    ds_read_b64_tr_b16 v[58:59], v10 offset:45568
    s_waitcnt lgkmcnt(6)
    v_mfma_f32_32x32x16_bf16 v[112:127], v[60:63], v[232:235], v[112:127]
    ds_read_b64_tr_b16 v[60:61], v11 offset:45056
    ds_read_b64_tr_b16 v[62:63], v11 offset:45568
    s_waitcnt lgkmcnt(6)
    v_mfma_f32_32x32x16_bf16 v[64:79], v[48:51], v[236:239], v[64:79]
    ds_read_b64_tr_b16 v[48:49], v8 offset:49152
    ds_read_b64_tr_b16 v[50:51], v8 offset:49664
    s_waitcnt lgkmcnt(6)
    v_mfma_f32_32x32x16_bf16 v[80:95], v[52:55], v[236:239], v[80:95]
    ds_read_b64_tr_b16 v[52:53], v9 offset:49152
    ds_read_b64_tr_b16 v[54:55], v9 offset:49664
    s_waitcnt lgkmcnt(6)
    v_mfma_f32_32x32x16_bf16 v[96:111], v[56:59], v[236:239], v[96:111]
    ds_read_b64_tr_b16 v[56:57], v10 offset:49152
    ds_read_b64_tr_b16 v[58:59], v10 offset:49664
    s_waitcnt lgkmcnt(6)
    v_mfma_f32_32x32x16_bf16 v[112:127], v[60:63], v[236:239], v[112:127]
    ds_read_b64_tr_b16 v[60:61], v11 offset:49152
    ds_read_b64_tr_b16 v[62:63], v11 offset:49664
    s_waitcnt lgkmcnt(6)
    v_mfma_f32_32x32x16_bf16 v[64:79], v[48:51], v[240:243], v[64:79]
    ds_read_b64_tr_b16 v[48:49], v8 offset:53248
    ds_read_b64_tr_b16 v[50:51], v8 offset:53760
    s_waitcnt lgkmcnt(6)
    v_mfma_f32_32x32x16_bf16 v[80:95], v[52:55], v[240:243], v[80:95]
    ds_read_b64_tr_b16 v[52:53], v9 offset:53248
    ds_read_b64_tr_b16 v[54:55], v9 offset:53760
    s_waitcnt vmcnt(4)
    s_mov_b64 exec, 1
    ds_add_u32 v14, v0
    s_mov_b64 exec, -1
    s_waitcnt lgkmcnt(7)
    v_mfma_f32_32x32x16_bf16 v[96:111], v[56:59], v[240:243], v[96:111]
    ds_read_b64_tr_b16 v[56:57], v10 offset:53248
    ds_read_b64_tr_b16 v[58:59], v10 offset:53760
    ds_read_b32 v15, v13
    s_waitcnt lgkmcnt(8)
    v_mfma_f32_32x32x16_bf16 v[112:127], v[60:63], v[240:243], v[112:127]
    ds_read_b64_tr_b16 v[60:61], v11 offset:53248
    ds_read_b64_tr_b16 v[62:63], v11 offset:53760
    s_waitcnt lgkmcnt(8)
    v_mfma_f32_32x32x16_bf16 v[64:79], v[48:51], v[244:247], v[64:79]
    ds_read_b64_tr_b16 v[48:49], v8 offset:57344
    ds_read_b64_tr_b16 v[50:51], v8 offset:57856
    s_waitcnt lgkmcnt(8)
    v_mfma_f32_32x32x16_bf16 v[80:95], v[52:55], v[244:247], v[80:95]
    ds_read_b64_tr_b16 v[52:53], v9 offset:57344
    ds_read_b64_tr_b16 v[54:55], v9 offset:57856
    s_waitcnt lgkmcnt(6)
    s_setprio 2
    s_mov_b32 s56, 0
    v_cmp_gt_u32 vcc, 9, v15
    s_cbranch_vccz L_spinx_54
L_spin_53:
    ds_read_b32 v15, v13
    s_add_u32 s56, s56, 1
    s_waitcnt lgkmcnt(0)
    v_cmp_gt_u32 vcc, 9, v15
    s_cmp_gt_u32 s56, 2000000
    s_cbranch_scc1 L_spinx_54
    s_cbranch_vccnz L_spin_53
L_spinx_54:
    s_setprio 0
    v_mfma_f32_32x32x16_bf16 v[96:111], v[56:59], v[244:247], v[96:111]
    ds_read_b64_tr_b16 v[56:57], v10 offset:57344
    ds_read_b64_tr_b16 v[58:59], v10 offset:57856
    s_add_u32 s50, s59, 2
    s_and_b32 s50, s50, 7
    s_mul_i32 s50, s50, 229376
    s_add_u32 s50, s50, s68
    s_add_u32 m0, s69, 32768
    s_add_u32 s50, s50, s78
    s_add_u32 s51, s50, 27648
    buffer_load_dwordx4 v5, s[24:27], s50 offen lds
    s_waitcnt lgkmcnt(6)
    v_mfma_f32_32x32x16_bf16 v[112:127], v[60:63], v[244:247], v[112:127]
    ds_read_b64_tr_b16 v[60:61], v11 offset:57344
    ds_read_b64_tr_b16 v[62:63], v11 offset:57856
    buffer_load_dwordx4 v5, s[24:27], s51 offen offset:1024 lds
    s_add_u32 m0, m0, 2048
    s_waitcnt lgkmcnt(6)
    v_mfma_f32_32x32x16_bf16 v[64:79], v[48:51], v[248:251], v[64:79]
    ds_read_b64_tr_b16 v[48:49], v8 offset:61440
    ds_read_b64_tr_b16 v[50:51], v8 offset:61952
    buffer_load_dwordx4 v6, s[28:31], s50 offen lds
    s_waitcnt lgkmcnt(6)
    v_mfma_f32_32x32x16_bf16 v[80:95], v[52:55], v[248:251], v[80:95]
    ds_read_b64_tr_b16 v[52:53], v9 offset:61440
    ds_read_b64_tr_b16 v[54:55], v9 offset:61952
    buffer_load_dwordx4 v6, s[28:31], s51 offen offset:1024 lds
    s_waitcnt lgkmcnt(6)
    v_mfma_f32_32x32x16_bf16 v[96:111], v[56:59], v[248:251], v[96:111]
    ds_read_b64_tr_b16 v[56:57], v10 offset:61440
    ds_read_b64_tr_b16 v[58:59], v10 offset:61952
    s_waitcnt lgkmcnt(6)
    v_mfma_f32_32x32x16_bf16 v[112:127], v[60:63], v[248:251], v[112:127]
    ds_read_b64_tr_b16 v[60:61], v11 offset:61440
    ds_read_b64_tr_b16 v[62:63], v11 offset:61952
    s_waitcnt lgkmcnt(6)
    v_mfma_f32_32x32x16_bf16 v[64:79], v[48:51], v[252:255], v[64:79]
    ds_read_b64_tr_b16 v[48:49], v8 offset:0
    ds_read_b64_tr_b16 v[50:51], v8 offset:512
    s_waitcnt lgkmcnt(6)
    v_mfma_f32_32x32x16_bf16 v[80:95], v[52:55], v[252:255], v[80:95]
    ds_read_b64_tr_b16 v[52:53], v9 offset:0
    ds_read_b64_tr_b16 v[54:55], v9 offset:512
    s_waitcnt lgkmcnt(6)
    v_mfma_f32_32x32x16_bf16 v[96:111], v[56:59], v[252:255], v[96:111]
    ds_read_b64_tr_b16 v[56:57], v10 offset:0
    ds_read_b64_tr_b16 v[58:59], v10 offset:512
    s_waitcnt lgkmcnt(6)
    v_mfma_f32_32x32x16_bf16 v[112:127], v[60:63], v[252:255], v[112:127]
    ds_read_b64_tr_b16 v[60:61], v8 offset:4096
    ds_read_b64_tr_b16 v[62:63], v8 offset:4608
    s_setprio 2
    s_add_u32 s80, s0, 0
    s_and_b32 s80, s80, 15
    s_add_u32 s80, s80, s60
    s_add_u32 m0, s76, 0
    s_lshl_b32 s50, s80, 14
    s_add_u32 s50, s50, s74
    s_add_u32 s51, s50, 7168
    buffer_load_dwordx4 v7, s[32:35], s50 offen lds
    buffer_load_dwordx4 v7, s[32:35], s51 offen offset:1024 lds
    s_add_u32 s80, s0, 1
    s_and_b32 s80, s80, 15
    s_add_u32 s80, s80, s60
    s_add_u32 m0, s76, 2048
    s_lshl_b32 s50, s80, 14
    s_add_u32 s50, s50, s74
    s_add_u32 s51, s50, 7168
    buffer_load_dwordx4 v7, s[32:35], s50 offen lds
    buffer_load_dwordx4 v7, s[32:35], s51 offen offset:1024 lds
    s_nop 7
    v_pk_mul_f32 v[16:17], v[64:65], s[62:63]
    v_pk_mul_f32 v[18:19], v[66:67], s[62:63]
    v_pk_mul_f32 v[20:21], v[68:69], s[62:63]
    v_pk_mul_f32 v[22:23], v[70:71], s[62:63]
    v_exp_f32 v16, v16
    v_exp_f32 v17, v17
    v_exp_f32 v18, v18
    v_exp_f32 v19, v19
    v_exp_f32 v20, v20
    v_exp_f32 v21, v21
    v_exp_f32 v22, v22
    v_exp_f32 v23, v23
    v_pk_mul_f32 v[64:65], v[64:65], v[72:73]
    v_pk_mul_f32 v[66:67], v[66:67], v[74:75]
    v_pk_mul_f32 v[68:69], v[68:69], v[76:77]
    v_pk_mul_f32 v[70:71], v[70:71], v[78:79]
    v_pk_add_f32 v[16:17], v[16:17], s[64:65]
    v_pk_add_f32 v[18:19], v[18:19], s[64:65]
    v_pk_add_f32 v[20:21], v[20:21], s[64:65]
    v_pk_add_f32 v[22:23], v[22:23], s[64:65]
    v_rcp_f32 v16, v16
    v_rcp_f32 v17, v17
    v_rcp_f32 v18, v18
    v_rcp_f32 v19, v19
    v_rcp_f32 v20, v20
    v_rcp_f32 v21, v21
    v_rcp_f32 v22, v22
    v_rcp_f32 v23, v23
    s_nop 0
    v_pk_mul_f32 v[64:65], v[64:65], v[16:17]
    v_pk_mul_f32 v[66:67], v[66:67], v[18:19]
    v_pk_mul_f32 v[68:69], v[68:69], v[20:21]
    v_pk_mul_f32 v[70:71], v[70:71], v[22:23]
    v_cvt_pk_bf16_f32 v24, v64, v65
    v_cvt_pk_bf16_f32 v25, v66, v67
    v_cvt_pk_bf16_f32 v26, v68, v69
    v_cvt_pk_bf16_f32 v27, v70, v71
    buffer_store_dwordx4 v[24:27], v2, s[8:11], s81 offen offset:0 sc1
    v_pk_mul_f32 v[16:17], v[80:81], s[62:63]
    v_pk_mul_f32 v[18:19], v[82:83], s[62:63]
    v_pk_mul_f32 v[20:21], v[84:85], s[62:63]
    v_pk_mul_f32 v[22:23], v[86:87], s[62:63]
    v_exp_f32 v16, v16
    v_exp_f32 v17, v17
    v_exp_f32 v18, v18
    v_exp_f32 v19, v19
    v_exp_f32 v20, v20
    v_exp_f32 v21, v21
    v_exp_f32 v22, v22
    v_exp_f32 v23, v23
    v_pk_mul_f32 v[80:81], v[80:81], v[88:89]
    v_pk_mul_f32 v[82:83], v[82:83], v[90:91]
    v_pk_mul_f32 v[84:85], v[84:85], v[92:93]
    v_pk_mul_f32 v[86:87], v[86:87], v[94:95]
    v_pk_add_f32 v[16:17], v[16:17], s[64:65]
    v_pk_add_f32 v[18:19], v[18:19], s[64:65]
    v_pk_add_f32 v[20:21], v[20:21], s[64:65]
    v_pk_add_f32 v[22:23], v[22:23], s[64:65]
    v_rcp_f32 v16, v16
    v_rcp_f32 v17, v17
    v_rcp_f32 v18, v18
    v_rcp_f32 v19, v19
    v_rcp_f32 v20, v20
    v_rcp_f32 v21, v21
    v_rcp_f32 v22, v22
    v_rcp_f32 v23, v23
    s_nop 0
    v_pk_mul_f32 v[80:81], v[80:81], v[16:17]
    v_pk_mul_f32 v[82:83], v[82:83], v[18:19]
    v_pk_mul_f32 v[84:85], v[84:85], v[20:21]
    v_pk_mul_f32 v[86:87], v[86:87], v[22:23]
    v_cvt_pk_bf16_f32 v28, v80, v81
    v_cvt_pk_bf16_f32 v29, v82, v83
    v_cvt_pk_bf16_f32 v30, v84, v85
    v_cvt_pk_bf16_f32 v31, v86, v87
    buffer_store_dwordx4 v[28:31], v2, s[8:11], s81 offen offset:1024 sc1
    v_pk_mul_f32 v[16:17], v[96:97], s[62:63]
    v_pk_mul_f32 v[18:19], v[98:99], s[62:63]
    v_pk_mul_f32 v[20:21], v[100:101], s[62:63]
    v_pk_mul_f32 v[22:23], v[102:103], s[62:63]
    v_exp_f32 v16, v16
    v_exp_f32 v17, v17
    v_exp_f32 v18, v18
    v_exp_f32 v19, v19
    v_exp_f32 v20, v20
    v_exp_f32 v21, v21
    v_exp_f32 v22, v22
    v_exp_f32 v23, v23
    v_pk_mul_f32 v[96:97], v[96:97], v[104:105]
    v_pk_mul_f32 v[98:99], v[98:99], v[106:107]
    v_pk_mul_f32 v[100:101], v[100:101], v[108:109]
    v_pk_mul_f32 v[102:103], v[102:103], v[110:111]
    v_pk_add_f32 v[16:17], v[16:17], s[64:65]
    v_pk_add_f32 v[18:19], v[18:19], s[64:65]
    v_pk_add_f32 v[20:21], v[20:21], s[64:65]
    v_pk_add_f32 v[22:23], v[22:23], s[64:65]
    v_rcp_f32 v16, v16
    v_rcp_f32 v17, v17
    v_rcp_f32 v18, v18
    v_rcp_f32 v19, v19
    v_rcp_f32 v20, v20
    v_rcp_f32 v21, v21
    v_rcp_f32 v22, v22
    v_rcp_f32 v23, v23
    s_nop 0
    v_pk_mul_f32 v[96:97], v[96:97], v[16:17]
    v_pk_mul_f32 v[98:99], v[98:99], v[18:19]
    v_pk_mul_f32 v[100:101], v[100:101], v[20:21]
    v_pk_mul_f32 v[102:103], v[102:103], v[22:23]
    v_cvt_pk_bf16_f32 v24, v96, v97
    v_cvt_pk_bf16_f32 v25, v98, v99
    v_cvt_pk_bf16_f32 v26, v100, v101
    v_cvt_pk_bf16_f32 v27, v102, v103
    buffer_store_dwordx4 v[24:27], v2, s[8:11], s81 offen offset:2048 sc1
    v_pk_mul_f32 v[16:17], v[112:113], s[62:63]
    v_pk_mul_f32 v[18:19], v[114:115], s[62:63]
    v_pk_mul_f32 v[20:21], v[116:117], s[62:63]
    v_pk_mul_f32 v[22:23], v[118:119], s[62:63]
    v_exp_f32 v16, v16
    v_exp_f32 v17, v17
    v_exp_f32 v18, v18
    v_exp_f32 v19, v19
    v_exp_f32 v20, v20
    v_exp_f32 v21, v21
    v_exp_f32 v22, v22
    v_exp_f32 v23, v23
    v_pk_mul_f32 v[112:113], v[112:113], v[120:121]
    v_pk_mul_f32 v[114:115], v[114:115], v[122:123]
    v_pk_mul_f32 v[116:117], v[116:117], v[124:125]
    v_pk_mul_f32 v[118:119], v[118:119], v[126:127]
    v_pk_add_f32 v[16:17], v[16:17], s[64:65]
    v_pk_add_f32 v[18:19], v[18:19], s[64:65]
    v_pk_add_f32 v[20:21], v[20:21], s[64:65]
    v_pk_add_f32 v[22:23], v[22:23], s[64:65]
    v_rcp_f32 v16, v16
    v_rcp_f32 v17, v17
    v_rcp_f32 v18, v18
    v_rcp_f32 v19, v19
    v_rcp_f32 v20, v20
    v_rcp_f32 v21, v21
    v_rcp_f32 v22, v22
    v_rcp_f32 v23, v23
    s_nop 0
    v_pk_mul_f32 v[112:113], v[112:113], v[16:17]
    v_pk_mul_f32 v[114:115], v[114:115], v[18:19]
    v_pk_mul_f32 v[116:117], v[116:117], v[20:21]
    v_pk_mul_f32 v[118:119], v[118:119], v[22:23]
    v_cvt_pk_bf16_f32 v28, v112, v113
    v_cvt_pk_bf16_f32 v29, v114, v115
    v_cvt_pk_bf16_f32 v30, v116, v117
    v_cvt_pk_bf16_f32 v31, v118, v119
    buffer_store_dwordx4 v[28:31], v2, s[8:11], s81 offen offset:3072 sc1
    s_setprio 0
    s_waitcnt lgkmcnt(6)
    v_mfma_f32_32x32x16_bf16 v[64:79], v[48:51], v[128:131], 0
    ds_read_b64_tr_b16 v[48:49], v9 offset:4096
    ds_read_b64_tr_b16 v[50:51], v9 offset:4608
    s_waitcnt lgkmcnt(6)
    v_mfma_f32_32x32x16_bf16 v[80:95], v[52:55], v[128:131], 0
    ds_read_b64_tr_b16 v[52:53], v10 offset:4096
    ds_read_b64_tr_b16 v[54:55], v10 offset:4608
    s_waitcnt vmcnt(12)
    s_mov_b64 exec, 1
    ds_add_u32 v14, v0
    s_mov_b64 exec, -1
    s_waitcnt lgkmcnt(7)
    v_mfma_f32_32x32x16_bf16 v[96:111], v[56:59], v[128:131], 0
    ds_read_b64_tr_b16 v[56:57], v8 offset:8192
    ds_read_b64_tr_b16 v[58:59], v8 offset:8704
    ds_read_b32 v15, v13
    s_waitcnt lgkmcnt(8)
    v_mfma_f32_32x32x16_bf16 v[64:79], v[60:63], v[132:135], v[64:79]
    ds_read_b64_tr_b16 v[60:61], v9 offset:8192
    ds_read_b64_tr_b16 v[62:63], v9 offset:8704
    s_waitcnt lgkmcnt(8)
    v_mfma_f32_32x32x16_bf16 v[80:95], v[48:51], v[132:135], v[80:95]
    ds_read_b64_tr_b16 v[48:49], v10 offset:8192
    ds_read_b64_tr_b16 v[50:51], v10 offset:8704
    s_waitcnt lgkmcnt(8)
    v_mfma_f32_32x32x16_bf16 v[96:111], v[52:55], v[132:135], v[96:111]
    ds_read_b64_tr_b16 v[52:53], v8 offset:12288
    ds_read_b64_tr_b16 v[54:55], v8 offset:12800
    s_waitcnt lgkmcnt(6)
    s_setprio 2
    s_mov_b32 s56, 0
    v_cmp_gt_u32 vcc, 10, v15
    s_cbranch_vccz L_spinx_56
L_spin_55:
    ds_read_b32 v15, v13
    s_add_u32 s56, s56, 1
    s_waitcnt lgkmcnt(0)
    v_cmp_gt_u32 vcc, 10, v15
    s_cmp_gt_u32 s56, 2000000
    s_cbranch_scc1 L_spinx_56
    s_cbranch_vccnz L_spin_55
L_spinx_56:
    s_setprio 0
    v_mfma_f32_32x32x16_bf16 v[64:79], v[56:59], v[136:139], v[64:79]
    ds_read_b64_tr_b16 v[56:57], v9 offset:12288
    ds_read_b64_tr_b16 v[58:59], v9 offset:12800
    s_add_u32 s50, s59, 3
    s_and_b32 s50, s50, 7
    s_mul_i32 s50, s50, 229376
    s_add_u32 s50, s50, s68
    s_add_u32 m0, s69, 49152
    s_add_u32 s50, s50, s78
    s_add_u32 s51, s50, 27648
    buffer_load_dwordx4 v5, s[24:27], s50 offen lds
    s_waitcnt lgkmcnt(6)
    v_mfma_f32_32x32x16_bf16 v[80:95], v[60:63], v[136:139], v[80:95]
    ds_read_b64_tr_b16 v[60:61], v10 offset:12288
    ds_read_b64_tr_b16 v[62:63], v10 offset:12800
    buffer_load_dwordx4 v5, s[24:27], s51 offen offset:1024 lds
    s_add_u32 m0, m0, 2048
    s_waitcnt lgkmcnt(6)
    v_mfma_f32_32x32x16_bf16 v[96:111], v[48:51], v[136:139], v[96:111]
    ds_read_b64_tr_b16 v[48:49], v8 offset:16384
    ds_read_b64_tr_b16 v[50:51], v8 offset:16896
    buffer_load_dwordx4 v6, s[28:31], s50 offen lds
    s_waitcnt lgkmcnt(6)
    v_mfma_f32_32x32x16_bf16 v[64:79], v[52:55], v[140:143], v[64:79]
    ds_read_b64_tr_b16 v[52:53], v9 offset:16384
    ds_read_b64_tr_b16 v[54:55], v9 offset:16896
    buffer_load_dwordx4 v6, s[28:31], s51 offen offset:1024 lds
    s_waitcnt lgkmcnt(6)
    v_mfma_f32_32x32x16_bf16 v[80:95], v[56:59], v[140:143], v[80:95]
    ds_read_b64_tr_b16 v[56:57], v10 offset:16384
    ds_read_b64_tr_b16 v[58:59], v10 offset:16896
    s_waitcnt lgkmcnt(6)
    v_mfma_f32_32x32x16_bf16 v[96:111], v[60:63], v[140:143], v[96:111]
    ds_read_b64_tr_b16 v[60:61], v8 offset:20480
    ds_read_b64_tr_b16 v[62:63], v8 offset:20992
    s_waitcnt lgkmcnt(6)
    v_mfma_f32_32x32x16_bf16 v[64:79], v[48:51], v[144:147], v[64:79]
    ds_read_b64_tr_b16 v[48:49], v9 offset:20480
    ds_read_b64_tr_b16 v[50:51], v9 offset:20992
    s_waitcnt lgkmcnt(6)
    v_mfma_f32_32x32x16_bf16 v[80:95], v[52:55], v[144:147], v[80:95]
    ds_read_b64_tr_b16 v[52:53], v10 offset:20480
    ds_read_b64_tr_b16 v[54:55], v10 offset:20992
    s_waitcnt vmcnt(12)
    s_mov_b64 exec, 1
    ds_add_u32 v14, v0
    s_mov_b64 exec, -1
    s_waitcnt lgkmcnt(7)
    v_mfma_f32_32x32x16_bf16 v[96:111], v[56:59], v[144:147], v[96:111]
    ds_read_b64_tr_b16 v[56:57], v8 offset:24576
    ds_read_b64_tr_b16 v[58:59], v8 offset:25088
    ds_read_b32 v15, v13
    s_waitcnt lgkmcnt(8)
    v_mfma_f32_32x32x16_bf16 v[64:79], v[60:63], v[148:151], v[64:79]
    ds_read_b64_tr_b16 v[60:61], v9 offset:24576
    ds_read_b64_tr_b16 v[62:63], v9 offset:25088
    s_waitcnt lgkmcnt(8)
    v_mfma_f32_32x32x16_bf16 v[80:95], v[48:51], v[148:151], v[80:95]
    ds_read_b64_tr_b16 v[48:49], v10 offset:24576
    ds_read_b64_tr_b16 v[50:51], v10 offset:25088
    s_waitcnt lgkmcnt(8)
    v_mfma_f32_32x32x16_bf16 v[96:111], v[52:55], v[148:151], v[96:111]
    ds_read_b64_tr_b16 v[52:53], v8 offset:28672
    ds_read_b64_tr_b16 v[54:55], v8 offset:29184
    s_waitcnt lgkmcnt(6)
    s_setprio 2
    s_mov_b32 s56, 0
    v_cmp_gt_u32 vcc, 11, v15
    s_cbranch_vccz L_spinx_58
L_spin_57:
    ds_read_b32 v15, v13
    s_add_u32 s56, s56, 1
    s_waitcnt lgkmcnt(0)
    v_cmp_gt_u32 vcc, 11, v15
    s_cmp_gt_u32 s56, 2000000
    s_cbranch_scc1 L_spinx_58
    s_cbranch_vccnz L_spin_57
L_spinx_58:
    s_setprio 0
    v_mfma_f32_32x32x16_bf16 v[64:79], v[56:59], v[152:155], v[64:79]
    ds_read_b64_tr_b16 v[56:57], v9 offset:28672
    ds_read_b64_tr_b16 v[58:59], v9 offset:29184
    s_add_u32 s50, s59, 4
    s_and_b32 s50, s50, 7
    s_mul_i32 s50, s50, 229376
    s_add_u32 s50, s50, s68
    s_add_u32 m0, s69, 0
    s_add_u32 s50, s50, s78
    s_add_u32 s51, s50, 27648
    buffer_load_dwordx4 v5, s[24:27], s50 offen lds
    s_waitcnt lgkmcnt(6)
    v_mfma_f32_32x32x16_bf16 v[80:95], v[60:63], v[152:155], v[80:95]
    ds_read_b64_tr_b16 v[60:61], v10 offset:28672
    ds_read_b64_tr_b16 v[62:63], v10 offset:29184
    buffer_load_dwordx4 v5, s[24:27], s51 offen offset:1024 lds
    s_add_u32 m0, m0, 2048
    s_waitcnt lgkmcnt(6)
    v_mfma_f32_32x32x16_bf16 v[96:111], v[48:51], v[152:155], v[96:111]
    ds_read_b64_tr_b16 v[48:49], v8 offset:32768
    ds_read_b64_tr_b16 v[50:51], v8 offset:33280
    buffer_load_dwordx4 v6, s[28:31], s50 offen lds
    s_waitcnt lgkmcnt(6)
    v_mfma_f32_32x32x16_bf16 v[64:79], v[52:55], v[156:159], v[64:79]
    ds_read_b64_tr_b16 v[52:53], v9 offset:32768
    ds_read_b64_tr_b16 v[54:55], v9 offset:33280
    buffer_load_dwordx4 v6, s[28:31], s51 offen offset:1024 lds
    s_waitcnt lgkmcnt(6)
    v_mfma_f32_32x32x16_bf16 v[80:95], v[56:59], v[156:159], v[80:95]
    ds_read_b64_tr_b16 v[56:57], v10 offset:32768
    ds_read_b64_tr_b16 v[58:59], v10 offset:33280
    s_waitcnt lgkmcnt(6)
    v_mfma_f32_32x32x16_bf16 v[96:111], v[60:63], v[156:159], v[96:111]
    ds_read_b64_tr_b16 v[60:61], v8 offset:36864
    ds_read_b64_tr_b16 v[62:63], v8 offset:37376
    s_lshl_b32 s52, s44, 12
    s_add_u32 m0, s52, 131072
    s_and_b32 s50, s77, 0xffffff80
    buffer_load_dwordx4 v32, s[4:7], s50 offen offset:0 lds
    s_add_u32 s50, s50, 7168
    buffer_load_dwordx4 v32, s[4:7], s50 offen offset:1024 lds
    s_add_u32 s50, s50, 7168
    buffer_load_dwordx4 v32, s[4:7], s50 offen offset:2048 lds
    s_add_u32 s50, s50, 7168
    buffer_load_dwordx4 v32, s[4:7], s50 offen offset:3072 lds
    s_waitcnt lgkmcnt(6)
    v_mfma_f32_32x32x16_bf16 v[64:79], v[48:51], v[160:163], v[64:79]
    ds_read_b64_tr_b16 v[48:49], v9 offset:36864
    ds_read_b64_tr_b16 v[50:51], v9 offset:37376
    s_waitcnt lgkmcnt(6)
    v_mfma_f32_32x32x16_bf16 v[80:95], v[52:55], v[160:163], v[80:95]
    ds_read_b64_tr_b16 v[52:53], v10 offset:36864
    ds_read_b64_tr_b16 v[54:55], v10 offset:37376
    s_waitcnt vmcnt(8)
    s_mov_b64 exec, 1
    ds_add_u32 v14, v0
    s_mov_b64 exec, -1
    s_waitcnt lgkmcnt(7)
    v_mfma_f32_32x32x16_bf16 v[96:111], v[56:59], v[160:163], v[96:111]
    ds_read_b64_tr_b16 v[56:57], v8 offset:40960
    ds_read_b64_tr_b16 v[58:59], v8 offset:41472
    ds_read_b32 v15, v13
    s_waitcnt lgkmcnt(8)
    v_mfma_f32_32x32x16_bf16 v[64:79], v[60:63], v[164:167], v[64:79]
    ds_read_b64_tr_b16 v[60:61], v9 offset:40960
    ds_read_b64_tr_b16 v[62:63], v9 offset:41472
    s_mov_b64 exec, 1
    buffer_store_dword v44, v45, s[8:11], s101 offen sc1
    s_mov_b64 exec, -1
    s_waitcnt lgkmcnt(8)
    v_mfma_f32_32x32x16_bf16 v[80:95], v[48:51], v[164:167], v[80:95]
    ds_read_b64_tr_b16 v[48:49], v10 offset:40960
    ds_read_b64_tr_b16 v[50:51], v10 offset:41472
    s_waitcnt lgkmcnt(8)
    v_mfma_f32_32x32x16_bf16 v[96:111], v[52:55], v[164:167], v[96:111]
    ds_read_b64_tr_b16 v[52:53], v8 offset:45056
    ds_read_b64_tr_b16 v[54:55], v8 offset:45568
    s_waitcnt lgkmcnt(6)
    s_setprio 2
    s_mov_b32 s56, 0
    v_cmp_gt_u32 vcc, 12, v15
    s_cbranch_vccz L_spinx_60
L_spin_59:
    ds_read_b32 v15, v13
    s_add_u32 s56, s56, 1
    s_waitcnt lgkmcnt(0)
    v_cmp_gt_u32 vcc, 12, v15
    s_cmp_gt_u32 s56, 2000000
    s_cbranch_scc1 L_spinx_60
    s_cbranch_vccnz L_spin_59
L_spinx_60:
    s_setprio 0
    v_mfma_f32_32x32x16_bf16 v[64:79], v[56:59], v[168:171], v[64:79]
    ds_read_b64_tr_b16 v[56:57], v9 offset:45056
    ds_read_b64_tr_b16 v[58:59], v9 offset:45568
    s_add_u32 s50, s59, 5
    s_and_b32 s50, s50, 7
    s_mul_i32 s50, s50, 229376
    s_add_u32 s50, s50, s68
    s_add_u32 m0, s69, 16384
    s_add_u32 s50, s50, s78
    s_add_u32 s51, s50, 27648
    buffer_load_dwordx4 v5, s[24:27], s50 offen lds
    s_waitcnt lgkmcnt(6)
    v_mfma_f32_32x32x16_bf16 v[80:95], v[60:63], v[168:171], v[80:95]
    ds_read_b64_tr_b16 v[60:61], v10 offset:45056
    ds_read_b64_tr_b16 v[62:63], v10 offset:45568
    buffer_load_dwordx4 v5, s[24:27], s51 offen offset:1024 lds
    s_add_u32 m0, m0, 2048
    s_waitcnt lgkmcnt(6)
    v_mfma_f32_32x32x16_bf16 v[96:111], v[48:51], v[168:171], v[96:111]
    ds_read_b64_tr_b16 v[48:49], v8 offset:49152
    ds_read_b64_tr_b16 v[50:51], v8 offset:49664
    buffer_load_dwordx4 v6, s[28:31], s50 offen lds
    s_waitcnt lgkmcnt(6)
    v_mfma_f32_32x32x16_bf16 v[64:79], v[52:55], v[172:175], v[64:79]
    ds_read_b64_tr_b16 v[52:53], v9 offset:49152
    ds_read_b64_tr_b16 v[54:55], v9 offset:49664
    buffer_load_dwordx4 v6, s[28:31], s51 offen offset:1024 lds
    s_waitcnt lgkmcnt(6)
    v_mfma_f32_32x32x16_bf16 v[80:95], v[56:59], v[172:175], v[80:95]
    ds_read_b64_tr_b16 v[56:57], v10 offset:49152
    ds_read_b64_tr_b16 v[58:59], v10 offset:49664
    s_add_u32 s80, s0, 2
    s_and_b32 s80, s80, 15
    s_add_u32 s80, s80, s60
    s_add_u32 m0, s76, 4096
    s_lshl_b32 s50, s80, 14
    s_add_u32 s50, s50, s74
    s_add_u32 s51, s50, 7168
    buffer_load_dwordx4 v7, s[32:35], s50 offen lds
    buffer_load_dwordx4 v7, s[32:35], s51 offen offset:1024 lds
    s_waitcnt lgkmcnt(6)
    v_mfma_f32_32x32x16_bf16 v[96:111], v[60:63], v[172:175], v[96:111]
    ds_read_b64_tr_b16 v[60:61], v8 offset:53248
    ds_read_b64_tr_b16 v[62:63], v8 offset:53760
    s_add_u32 s80, s0, 3
    s_and_b32 s80, s80, 15
    s_add_u32 s80, s80, s60
    s_add_u32 m0, s76, 6144
    s_lshl_b32 s50, s80, 14
    s_add_u32 s50, s50, s74
    s_add_u32 s51, s50, 7168
    buffer_load_dwordx4 v7, s[32:35], s50 offen lds
    buffer_load_dwordx4 v7, s[32:35], s51 offen offset:1024 lds
    s_waitcnt lgkmcnt(6)
    v_mfma_f32_32x32x16_bf16 v[64:79], v[48:51], v[176:179], v[64:79]
    ds_read_b64_tr_b16 v[48:49], v9 offset:53248
    ds_read_b64_tr_b16 v[50:51], v9 offset:53760
    s_waitcnt lgkmcnt(6)
    v_mfma_f32_32x32x16_bf16 v[80:95], v[52:55], v[176:179], v[80:95]
    ds_read_b64_tr_b16 v[52:53], v10 offset:53248
    ds_read_b64_tr_b16 v[54:55], v10 offset:53760
    s_waitcnt vmcnt(13)
    s_mov_b64 exec, 1
    ds_add_u32 v14, v0
    s_mov_b64 exec, -1
    s_waitcnt lgkmcnt(7)
    v_mfma_f32_32x32x16_bf16 v[96:111], v[56:59], v[176:179], v[96:111]
    ds_read_b64_tr_b16 v[56:57], v8 offset:57344
    ds_read_b64_tr_b16 v[58:59], v8 offset:57856
    ds_read_b32 v15, v13
    s_waitcnt lgkmcnt(8)
    v_mfma_f32_32x32x16_bf16 v[64:79], v[60:63], v[180:183], v[64:79]
    ds_read_b64_tr_b16 v[60:61], v9 offset:57344
    ds_read_b64_tr_b16 v[62:63], v9 offset:57856
    s_waitcnt lgkmcnt(8)
    v_mfma_f32_32x32x16_bf16 v[80:95], v[48:51], v[180:183], v[80:95]
    ds_read_b64_tr_b16 v[48:49], v10 offset:57344
    ds_read_b64_tr_b16 v[50:51], v10 offset:57856
    s_waitcnt lgkmcnt(8)
    v_mfma_f32_32x32x16_bf16 v[96:111], v[52:55], v[180:183], v[96:111]
    ds_read_b64_tr_b16 v[52:53], v8 offset:61440
    ds_read_b64_tr_b16 v[54:55], v8 offset:61952
    s_waitcnt lgkmcnt(6)
    s_setprio 2
    s_mov_b32 s56, 0
    v_cmp_gt_u32 vcc, 13, v15
    s_cbranch_vccz L_spinx_62
L_spin_61:
    ds_read_b32 v15, v13
    s_add_u32 s56, s56, 1
    s_waitcnt lgkmcnt(0)
    v_cmp_gt_u32 vcc, 13, v15
    s_cmp_gt_u32 s56, 2000000
    s_cbranch_scc1 L_spinx_62
    s_cbranch_vccnz L_spin_61
L_spinx_62:
    s_setprio 0
    v_mfma_f32_32x32x16_bf16 v[64:79], v[56:59], v[184:187], v[64:79]
    ds_read_b64_tr_b16 v[56:57], v9 offset:61440
    ds_read_b64_tr_b16 v[58:59], v9 offset:61952
    s_add_u32 s50, s59, 6
    s_and_b32 s50, s50, 7
    s_mul_i32 s50, s50, 229376
    s_add_u32 s50, s50, s68
    s_add_u32 m0, s69, 32768
    s_add_u32 s50, s50, s78
    s_add_u32 s51, s50, 27648
    buffer_load_dwordx4 v5, s[24:27], s50 offen lds
    s_waitcnt lgkmcnt(6)
    v_mfma_f32_32x32x16_bf16 v[80:95], v[60:63], v[184:187], v[80:95]
    ds_read_b64_tr_b16 v[60:61], v10 offset:61440
    ds_read_b64_tr_b16 v[62:63], v10 offset:61952
    buffer_load_dwordx4 v5, s[24:27], s51 offen offset:1024 lds
    s_add_u32 m0, m0, 2048
    s_waitcnt lgkmcnt(6)
    v_mfma_f32_32x32x16_bf16 v[96:111], v[48:51], v[184:187], v[96:111]
    ds_read_b64_tr_b16 v[48:49], v8 offset:0
    ds_read_b64_tr_b16 v[50:51], v8 offset:512
    buffer_load_dwordx4 v6, s[28:31], s50 offen lds
    s_waitcnt lgkmcnt(6)
    v_mfma_f32_32x32x16_bf16 v[64:79], v[52:55], v[188:191], v[64:79]
    ds_read_b64_tr_b16 v[52:53], v9 offset:0
    ds_read_b64_tr_b16 v[54:55], v9 offset:512
    buffer_load_dwordx4 v6, s[28:31], s51 offen offset:1024 lds
    s_waitcnt lgkmcnt(6)
    v_mfma_f32_32x32x16_bf16 v[80:95], v[56:59], v[188:191], v[80:95]
    ds_read_b64_tr_b16 v[56:57], v10 offset:0
    ds_read_b64_tr_b16 v[58:59], v10 offset:512
    s_waitcnt lgkmcnt(6)
    v_mfma_f32_32x32x16_bf16 v[96:111], v[60:63], v[188:191], v[96:111]
    ds_read_b64_tr_b16 v[60:61], v8 offset:4096
    ds_read_b64_tr_b16 v[62:63], v8 offset:4608
    s_waitcnt lgkmcnt(6)
    v_mfma_f32_32x32x16_bf16 v[64:79], v[48:51], v[192:195], v[64:79]
    ds_read_b64_tr_b16 v[48:49], v9 offset:4096
    ds_read_b64_tr_b16 v[50:51], v9 offset:4608
    s_waitcnt lgkmcnt(6)
    v_mfma_f32_32x32x16_bf16 v[80:95], v[52:55], v[192:195], v[80:95]
    ds_read_b64_tr_b16 v[52:53], v10 offset:4096
    ds_read_b64_tr_b16 v[54:55], v10 offset:4608
    s_waitcnt vmcnt(8)
    s_mov_b64 exec, 1
    ds_add_u32 v14, v0
    s_mov_b64 exec, -1
    s_waitcnt lgkmcnt(7)
    v_mfma_f32_32x32x16_bf16 v[96:111], v[56:59], v[192:195], v[96:111]
    ds_read_b64_tr_b16 v[56:57], v8 offset:8192
    ds_read_b64_tr_b16 v[58:59], v8 offset:8704
    ds_read_b32 v15, v13
    s_waitcnt lgkmcnt(8)
    v_mfma_f32_32x32x16_bf16 v[64:79], v[60:63], v[196:199], v[64:79]
    ds_read_b64_tr_b16 v[60:61], v9 offset:8192
    ds_read_b64_tr_b16 v[62:63], v9 offset:8704
    s_waitcnt lgkmcnt(8)
    v_mfma_f32_32x32x16_bf16 v[80:95], v[48:51], v[196:199], v[80:95]
    ds_read_b64_tr_b16 v[48:49], v10 offset:8192
    ds_read_b64_tr_b16 v[50:51], v10 offset:8704
    s_waitcnt lgkmcnt(8)
    v_mfma_f32_32x32x16_bf16 v[96:111], v[52:55], v[196:199], v[96:111]
    ds_read_b64_tr_b16 v[52:53], v8 offset:12288
    ds_read_b64_tr_b16 v[54:55], v8 offset:12800
    s_waitcnt lgkmcnt(6)
    s_setprio 2
    s_mov_b32 s56, 0
    v_cmp_gt_u32 vcc, 14, v15
    s_cbranch_vccz L_spinx_64
L_spin_63:
    ds_read_b32 v15, v13
    s_add_u32 s56, s56, 1
    s_waitcnt lgkmcnt(0)
    v_cmp_gt_u32 vcc, 14, v15
    s_cmp_gt_u32 s56, 2000000
    s_cbranch_scc1 L_spinx_64
    s_cbranch_vccnz L_spin_63
L_spinx_64:
    s_setprio 0
    v_mfma_f32_32x32x16_bf16 v[64:79], v[56:59], v[200:203], v[64:79]
    ds_read_b64_tr_b16 v[56:57], v9 offset:12288
    ds_read_b64_tr_b16 v[58:59], v9 offset:12800
    s_add_u32 s50, s59, 7
    s_and_b32 s50, s50, 7
    s_mul_i32 s50, s50, 229376
    s_add_u32 s50, s50, s68
    s_add_u32 m0, s69, 49152
    s_add_u32 s50, s50, s78
    s_add_u32 s51, s50, 27648
    buffer_load_dwordx4 v5, s[24:27], s50 offen lds
    s_waitcnt lgkmcnt(6)
    v_mfma_f32_32x32x16_bf16 v[80:95], v[60:63], v[200:203], v[80:95]
    ds_read_b64_tr_b16 v[60:61], v10 offset:12288
    ds_read_b64_tr_b16 v[62:63], v10 offset:12800
    buffer_load_dwordx4 v5, s[24:27], s51 offen offset:1024 lds
    s_add_u32 m0, m0, 2048
    s_waitcnt lgkmcnt(6)
    v_mfma_f32_32x32x16_bf16 v[96:111], v[48:51], v[200:203], v[96:111]
    ds_read_b64_tr_b16 v[48:49], v8 offset:16384
    ds_read_b64_tr_b16 v[50:51], v8 offset:16896
    buffer_load_dwordx4 v6, s[28:31], s50 offen lds
    s_waitcnt lgkmcnt(6)
    v_mfma_f32_32x32x16_bf16 v[64:79], v[52:55], v[204:207], v[64:79]
    ds_read_b64_tr_b16 v[52:53], v9 offset:16384
    ds_read_b64_tr_b16 v[54:55], v9 offset:16896
    buffer_load_dwordx4 v6, s[28:31], s51 offen offset:1024 lds
    s_waitcnt lgkmcnt(6)
    v_mfma_f32_32x32x16_bf16 v[80:95], v[56:59], v[204:207], v[80:95]
    ds_read_b64_tr_b16 v[56:57], v10 offset:16384
    ds_read_b64_tr_b16 v[58:59], v10 offset:16896
    s_mov_b32 s53, 65536
    s_mov_b64 exec, 0xff
    buffer_load_dwordx2 v[46:47], v42, s[8:11], s53 offen sc1
    s_mov_b64 exec, -1
    s_add_u32 s80, s0, 4
    s_and_b32 s80, s80, 15
    s_add_u32 s80, s80, s60
    s_add_u32 m0, s76, 8192
    s_lshl_b32 s50, s80, 14
    s_add_u32 s50, s50, s74
    s_add_u32 s51, s50, 7168
    buffer_load_dwordx4 v7, s[32:35], s50 offen lds
    buffer_load_dwordx4 v7, s[32:35], s51 offen offset:1024 lds
    s_waitcnt lgkmcnt(6)
    v_mfma_f32_32x32x16_bf16 v[96:111], v[60:63], v[204:207], v[96:111]
    ds_read_b64_tr_b16 v[60:61], v8 offset:20480
    ds_read_b64_tr_b16 v[62:63], v8 offset:20992
    s_add_u32 s80, s0, 5
    s_and_b32 s80, s80, 15
    s_add_u32 s80, s80, s60
    s_add_u32 m0, s76, 10240
    s_lshl_b32 s50, s80, 14
    s_add_u32 s50, s50, s74
    s_add_u32 s51, s50, 7168
    buffer_load_dwordx4 v7, s[32:35], s50 offen lds
    buffer_load_dwordx4 v7, s[32:35], s51 offen offset:1024 lds
    s_waitcnt lgkmcnt(6)
    v_mfma_f32_32x32x16_bf16 v[64:79], v[48:51], v[208:211], v[64:79]
    ds_read_b64_tr_b16 v[48:49], v9 offset:20480
    ds_read_b64_tr_b16 v[50:51], v9 offset:20992
    s_waitcnt lgkmcnt(6)
    v_mfma_f32_32x32x16_bf16 v[80:95], v[52:55], v[208:211], v[80:95]
    ds_read_b64_tr_b16 v[52:53], v10 offset:20480
    ds_read_b64_tr_b16 v[54:55], v10 offset:20992
    s_waitcnt vmcnt(9)
    s_mov_b64 exec, 1
    ds_add_u32 v14, v0
    s_mov_b64 exec, -1
    s_waitcnt lgkmcnt(7)
    v_mfma_f32_32x32x16_bf16 v[96:111], v[56:59], v[208:211], v[96:111]
    ds_read_b64_tr_b16 v[56:57], v8 offset:24576
    ds_read_b64_tr_b16 v[58:59], v8 offset:25088
    ds_read_b32 v15, v13
    s_waitcnt lgkmcnt(8)
    v_mfma_f32_32x32x16_bf16 v[64:79], v[60:63], v[212:215], v[64:79]
    ds_read_b64_tr_b16 v[60:61], v9 offset:24576
    ds_read_b64_tr_b16 v[62:63], v9 offset:25088
    s_waitcnt lgkmcnt(8)
    v_mfma_f32_32x32x16_bf16 v[80:95], v[48:51], v[212:215], v[80:95]
    ds_read_b64_tr_b16 v[48:49], v10 offset:24576
    ds_read_b64_tr_b16 v[50:51], v10 offset:25088
    s_waitcnt lgkmcnt(8)
    v_mfma_f32_32x32x16_bf16 v[96:111], v[52:55], v[212:215], v[96:111]
    ds_read_b64_tr_b16 v[52:53], v8 offset:28672
    ds_read_b64_tr_b16 v[54:55], v8 offset:29184
    s_waitcnt lgkmcnt(6)
    s_setprio 2
    s_mov_b32 s56, 0
    v_cmp_gt_u32 vcc, 15, v15
    s_cbranch_vccz L_spinx_66
L_spin_65:
    ds_read_b32 v15, v13
    s_add_u32 s56, s56, 1
    s_waitcnt lgkmcnt(0)
    v_cmp_gt_u32 vcc, 15, v15
    s_cmp_gt_u32 s56, 2000000
    s_cbranch_scc1 L_spinx_66
    s_cbranch_vccnz L_spin_65
L_spinx_66:
    s_setprio 0
    v_mfma_f32_32x32x16_bf16 v[64:79], v[56:59], v[216:219], v[64:79]
    ds_read_b64_tr_b16 v[56:57], v9 offset:28672
    ds_read_b64_tr_b16 v[58:59], v9 offset:29184
    s_waitcnt lgkmcnt(6)
    v_mfma_f32_32x32x16_bf16 v[80:95], v[60:63], v[216:219], v[80:95]
    ds_read_b64_tr_b16 v[60:61], v10 offset:28672
    ds_read_b64_tr_b16 v[62:63], v10 offset:29184
    s_waitcnt lgkmcnt(6)
    v_mfma_f32_32x32x16_bf16 v[96:111], v[48:51], v[216:219], v[96:111]
    ds_read_b64_tr_b16 v[48:49], v8 offset:32768
    ds_read_b64_tr_b16 v[50:51], v8 offset:33280
    s_waitcnt lgkmcnt(6)
    v_mfma_f32_32x32x16_bf16 v[64:79], v[52:55], v[220:223], v[64:79]
    ds_read_b64_tr_b16 v[52:53], v9 offset:32768
    ds_read_b64_tr_b16 v[54:55], v9 offset:33280
    s_waitcnt lgkmcnt(6)
    v_mfma_f32_32x32x16_bf16 v[80:95], v[56:59], v[220:223], v[80:95]
    ds_read_b64_tr_b16 v[56:57], v10 offset:32768
    ds_read_b64_tr_b16 v[58:59], v10 offset:33280
    s_add_u32 s80, s0, 6
    s_and_b32 s80, s80, 15
    s_add_u32 s80, s80, s60
    s_add_u32 m0, s76, 12288
    s_lshl_b32 s50, s80, 14
    s_add_u32 s50, s50, s74
    s_add_u32 s51, s50, 7168
    buffer_load_dwordx4 v7, s[32:35], s50 offen lds
    buffer_load_dwordx4 v7, s[32:35], s51 offen offset:1024 lds
    s_waitcnt lgkmcnt(6)
    v_mfma_f32_32x32x16_bf16 v[96:111], v[60:63], v[220:223], v[96:111]
    ds_read_b64_tr_b16 v[60:61], v8 offset:36864
    ds_read_b64_tr_b16 v[62:63], v8 offset:37376
    s_setprio 2
    s_waitcnt vmcnt(6)
    s_mov_b32 s56, 0
    s_mov_b64 exec, 0xff
    v_cmp_ne_u32 vcc, s48, v46
    s_cbranch_vccz L_pollx_68
L_poll_67:
    buffer_load_dwordx2 v[46:47], v42, s[8:11], s53 offen sc1
    s_add_u32 s56, s56, 1
    s_waitcnt vmcnt(0)
    v_cmp_ne_u32 vcc, s48, v46
    s_cmp_gt_u32 s56, 200000
    s_cbranch_scc1 L_pollx_68
    s_cbranch_vccnz L_poll_67
L_pollx_68:
    s_mov_b64 exec, -1
    s_setprio 0
    s_add_u32 s80, s0, 7
    s_and_b32 s80, s80, 15
    s_add_u32 s80, s80, s60
    s_add_u32 m0, s76, 14336
    s_lshl_b32 s50, s80, 14
    s_add_u32 s50, s50, s74
    s_add_u32 s51, s50, 7168
    buffer_load_dwordx4 v7, s[32:35], s50 offen lds
    buffer_load_dwordx4 v7, s[32:35], s51 offen offset:1024 lds
    s_waitcnt lgkmcnt(6)
    v_mfma_f32_32x32x16_bf16 v[64:79], v[48:51], v[224:227], v[64:79]
    ds_read_b64_tr_b16 v[48:49], v9 offset:36864
    ds_read_b64_tr_b16 v[50:51], v9 offset:37376
    s_waitcnt lgkmcnt(6)
    v_mfma_f32_32x32x16_bf16 v[80:95], v[52:55], v[224:227], v[80:95]
    ds_read_b64_tr_b16 v[52:53], v10 offset:36864
    ds_read_b64_tr_b16 v[54:55], v10 offset:37376
    s_mov_b64 exec, 1
    ds_add_u32 v14, v0
    s_mov_b64 exec, -1
    s_add_u32 s80, s0, 0
    s_and_b32 s80, s80, 15
    s_add_u32 s80, s80, s60
    s_lshl_b32 s50, s80, 10
    s_add_u32 s51, s50, s70
    buffer_load_dwordx4 v[128:131], v2, s[8:11], s51 offen sc1
    s_add_u32 s51, s50, s71
    buffer_load_dwordx4 v[132:135], v2, s[8:11], s51 offen sc1
    s_waitcnt lgkmcnt(7)
    v_mfma_f32_32x32x16_bf16 v[96:111], v[56:59], v[224:227], v[96:111]
    ds_read_b64_tr_b16 v[56:57], v8 offset:40960
    ds_read_b64_tr_b16 v[58:59], v8 offset:41472
    ds_read_b32 v15, v13
    s_waitcnt lgkmcnt(8)
    v_mfma_f32_32x32x16_bf16 v[64:79], v[60:63], v[228:231], v[64:79]
    ds_read_b64_tr_b16 v[60:61], v9 offset:40960
    ds_read_b64_tr_b16 v[62:63], v9 offset:41472
    s_add_u32 s80, s0, 1
    s_and_b32 s80, s80, 15
    s_add_u32 s80, s80, s60
    s_lshl_b32 s50, s80, 10
    s_add_u32 s51, s50, s70
    buffer_load_dwordx4 v[136:139], v2, s[8:11], s51 offen sc1
    s_add_u32 s51, s50, s71
    buffer_load_dwordx4 v[140:143], v2, s[8:11], s51 offen sc1
    s_waitcnt lgkmcnt(8)
    v_mfma_f32_32x32x16_bf16 v[80:95], v[48:51], v[228:231], v[80:95]
    ds_read_b64_tr_b16 v[48:49], v10 offset:40960
    ds_read_b64_tr_b16 v[50:51], v10 offset:41472
    s_waitcnt lgkmcnt(8)
    v_mfma_f32_32x32x16_bf16 v[96:111], v[52:55], v[228:231], v[96:111]
    ds_read_b64_tr_b16 v[52:53], v8 offset:45056
    ds_read_b64_tr_b16 v[54:55], v8 offset:45568
    s_waitcnt lgkmcnt(6)
    s_setprio 2
    s_mov_b32 s56, 0
    v_cmp_gt_u32 vcc, 16, v15
    s_cbranch_vccz L_spinx_71
L_spin_70:
    ds_read_b32 v15, v13
    s_add_u32 s56, s56, 1
    s_waitcnt lgkmcnt(0)
    v_cmp_gt_u32 vcc, 16, v15
    s_cmp_gt_u32 s56, 2000000
    s_cbranch_scc1 L_spinx_71
    s_cbranch_vccnz L_spin_70
L_spinx_71:
    s_setprio 0
    s_add_u32 s80, s0, 2
    s_and_b32 s80, s80, 15
    s_add_u32 s80, s80, s60
    s_lshl_b32 s50, s80, 10
    s_add_u32 s51, s50, s70
    buffer_load_dwordx4 v[144:147], v2, s[8:11], s51 offen sc1
    s_add_u32 s51, s50, s71
    buffer_load_dwordx4 v[148:151], v2, s[8:11], s51 offen sc1
    v_mfma_f32_32x32x16_bf16 v[64:79], v[56:59], v[232:235], v[64:79]
    ds_read_b64_tr_b16 v[56:57], v9 offset:45056
    ds_read_b64_tr_b16 v[58:59], v9 offset:45568
    s_waitcnt lgkmcnt(6)
    v_mfma_f32_32x32x16_bf16 v[80:95], v[60:63], v[232:235], v[80:95]
    ds_read_b64_tr_b16 v[60:61], v10 offset:45056
    ds_read_b64_tr_b16 v[62:63], v10 offset:45568
    s_add_u32 s80, s0, 3
    s_and_b32 s80, s80, 15
    s_add_u32 s80, s80, s60
    s_lshl_b32 s50, s80, 10
    s_add_u32 s51, s50, s70
    buffer_load_dwordx4 v[152:155], v2, s[8:11], s51 offen sc1
    s_add_u32 s51, s50, s71
    buffer_load_dwordx4 v[156:159], v2, s[8:11], s51 offen sc1
    s_waitcnt lgkmcnt(6)
    v_mfma_f32_32x32x16_bf16 v[96:111], v[48:51], v[232:235], v[96:111]
    ds_read_b64_tr_b16 v[48:49], v8 offset:49152
    ds_read_b64_tr_b16 v[50:51], v8 offset:49664
    s_waitcnt lgkmcnt(6)
    v_mfma_f32_32x32x16_bf16 v[64:79], v[52:55], v[236:239], v[64:79]
    ds_read_b64_tr_b16 v[52:53], v9 offset:49152
    ds_read_b64_tr_b16 v[54:55], v9 offset:49664
    s_waitcnt lgkmcnt(6)
    v_mfma_f32_32x32x16_bf16 v[80:95], v[56:59], v[236:239], v[80:95]
    ds_read_b64_tr_b16 v[56:57], v10 offset:49152
    ds_read_b64_tr_b16 v[58:59], v10 offset:49664
    s_waitcnt lgkmcnt(6)
    v_mfma_f32_32x32x16_bf16 v[96:111], v[60:63], v[236:239], v[96:111]
    ds_read_b64_tr_b16 v[60:61], v8 offset:53248
    ds_read_b64_tr_b16 v[62:63], v8 offset:53760
    s_waitcnt lgkmcnt(6)
    v_mfma_f32_32x32x16_bf16 v[64:79], v[48:51], v[240:243], v[64:79]
    ds_read_b64_tr_b16 v[48:49], v9 offset:53248
    ds_read_b64_tr_b16 v[50:51], v9 offset:53760
    s_waitcnt lgkmcnt(6)
    v_mfma_f32_32x32x16_bf16 v[80:95], v[52:55], v[240:243], v[80:95]
    ds_read_b64_tr_b16 v[52:53], v10 offset:53248
    ds_read_b64_tr_b16 v[54:55], v10 offset:53760
    s_waitcnt lgkmcnt(6)
    v_mfma_f32_32x32x16_bf16 v[96:111], v[56:59], v[240:243], v[96:111]
    ds_read_b64_tr_b16 v[56:57], v8 offset:57344
    ds_read_b64_tr_b16 v[58:59], v8 offset:57856
    s_add_u32 s80, s0, 4
    s_and_b32 s80, s80, 15
    s_add_u32 s80, s80, s60
    s_lshl_b32 s50, s80, 10
    s_add_u32 s51, s50, s70
    buffer_load_dwordx4 v[160:163], v2, s[8:11], s51 offen sc1
    s_add_u32 s51, s50, s71
    buffer_load_dwordx4 v[164:167], v2, s[8:11], s51 offen sc1
    s_waitcnt lgkmcnt(6)
    v_mfma_f32_32x32x16_bf16 v[64:79], v[60:63], v[244:247], v[64:79]
    ds_read_b64_tr_b16 v[60:61], v9 offset:57344
    ds_read_b64_tr_b16 v[62:63], v9 offset:57856
    s_waitcnt lgkmcnt(6)
    v_mfma_f32_32x32x16_bf16 v[80:95], v[48:51], v[244:247], v[80:95]
    ds_read_b64_tr_b16 v[48:49], v10 offset:57344
    ds_read_b64_tr_b16 v[50:51], v10 offset:57856
    s_add_u32 s80, s0, 5
    s_and_b32 s80, s80, 15
    s_add_u32 s80, s80, s60
    s_lshl_b32 s50, s80, 10
    s_add_u32 s51, s50, s70
    buffer_load_dwordx4 v[168:171], v2, s[8:11], s51 offen sc1
    s_add_u32 s51, s50, s71
    buffer_load_dwordx4 v[172:175], v2, s[8:11], s51 offen sc1
    s_waitcnt lgkmcnt(6)
    v_mfma_f32_32x32x16_bf16 v[96:111], v[52:55], v[244:247], v[96:111]
    ds_read_b64_tr_b16 v[52:53], v8 offset:61440
    ds_read_b64_tr_b16 v[54:55], v8 offset:61952
    s_waitcnt lgkmcnt(6)
    v_mfma_f32_32x32x16_bf16 v[64:79], v[56:59], v[248:251], v[64:79]
    ds_read_b64_tr_b16 v[56:57], v9 offset:61440
    ds_read_b64_tr_b16 v[58:59], v9 offset:61952
    s_add_u32 s80, s0, 6
    s_and_b32 s80, s80, 15
    s_add_u32 s80, s80, s60
    s_lshl_b32 s50, s80, 10
    s_add_u32 s51, s50, s70
    buffer_load_dwordx4 v[176:179], v2, s[8:11], s51 offen sc1
    s_add_u32 s51, s50, s71
    buffer_load_dwordx4 v[180:183], v2, s[8:11], s51 offen sc1
    s_waitcnt lgkmcnt(6)
    v_mfma_f32_32x32x16_bf16 v[80:95], v[60:63], v[248:251], v[80:95]
    ds_read_b64_tr_b16 v[60:61], v10 offset:61440
    ds_read_b64_tr_b16 v[62:63], v10 offset:61952
    s_waitcnt lgkmcnt(6)
    v_mfma_f32_32x32x16_bf16 v[96:111], v[48:51], v[248:251], v[96:111]
    s_add_u32 s80, s0, 7
    s_and_b32 s80, s80, 15
    s_add_u32 s80, s80, s60
    s_lshl_b32 s50, s80, 10
    s_add_u32 s51, s50, s70
    buffer_load_dwordx4 v[184:187], v2, s[8:11], s51 offen sc1
    s_add_u32 s51, s50, s71
    buffer_load_dwordx4 v[188:191], v2, s[8:11], s51 offen sc1
    s_waitcnt lgkmcnt(4)
    v_mfma_f32_32x32x16_bf16 v[64:79], v[52:55], v[252:255], v[64:79]
    s_waitcnt lgkmcnt(2)
    v_mfma_f32_32x32x16_bf16 v[80:95], v[56:59], v[252:255], v[80:95]
    s_waitcnt lgkmcnt(0)
    v_mfma_f32_32x32x16_bf16 v[96:111], v[60:63], v[252:255], v[96:111]
    s_mov_b64 exec, 1
    ds_add_u32 v14, v0
    s_mov_b64 exec, -1
    s_setprio 2
    s_nop 7
    s_nop 1
    v_pk_mul_f32 v[16:17], v[64:65], s[62:63]
    v_pk_mul_f32 v[18:19], v[66:67], s[62:63]
    v_pk_mul_f32 v[20:21], v[68:69], s[62:63]
    v_pk_mul_f32 v[22:23], v[70:71], s[62:63]
    v_exp_f32 v16, v16
    v_exp_f32 v17, v17
    v_exp_f32 v18, v18
    v_exp_f32 v19, v19
    v_exp_f32 v20, v20
    v_exp_f32 v21, v21
    v_exp_f32 v22, v22
    v_exp_f32 v23, v23
    v_pk_mul_f32 v[64:65], v[64:65], v[72:73]
    v_pk_mul_f32 v[66:67], v[66:67], v[74:75]
    v_pk_mul_f32 v[68:69], v[68:69], v[76:77]
    v_pk_mul_f32 v[70:71], v[70:71], v[78:79]
    v_pk_add_f32 v[16:17], v[16:17], s[64:65]
    v_pk_add_f32 v[18:19], v[18:19], s[64:65]
    v_pk_add_f32 v[20:21], v[20:21], s[64:65]
    v_pk_add_f32 v[22:23], v[22:23], s[64:65]
    v_rcp_f32 v16, v16
    v_rcp_f32 v17, v17
    v_rcp_f32 v18, v18
    v_rcp_f32 v19, v19
    v_rcp_f32 v20, v20
    v_rcp_f32 v21, v21
    v_rcp_f32 v22, v22
    v_rcp_f32 v23, v23
    s_add_u32 s81, s81, s79
    v_pk_mul_f32 v[64:65], v[64:65], v[16:17]
    v_pk_mul_f32 v[66:67], v[66:67], v[18:19]
    v_pk_mul_f32 v[68:69], v[68:69], v[20:21]
    v_pk_mul_f32 v[70:71], v[70:71], v[22:23]
    v_cvt_pk_bf16_f32 v24, v64, v65
    v_cvt_pk_bf16_f32 v25, v66, v67
    v_cvt_pk_bf16_f32 v26, v68, v69
    v_cvt_pk_bf16_f32 v27, v70, v71
    buffer_store_dwordx4 v[24:27], v2, s[8:11], s81 offen offset:0 sc1
    v_pk_mul_f32 v[16:17], v[80:81], s[62:63]
    v_pk_mul_f32 v[18:19], v[82:83], s[62:63]
    v_pk_mul_f32 v[20:21], v[84:85], s[62:63]
    v_pk_mul_f32 v[22:23], v[86:87], s[62:63]
    v_exp_f32 v16, v16
    v_exp_f32 v17, v17
    v_exp_f32 v18, v18
    v_exp_f32 v19, v19
    v_exp_f32 v20, v20
    v_exp_f32 v21, v21
    v_exp_f32 v22, v22
    v_exp_f32 v23, v23
    v_pk_mul_f32 v[80:81], v[80:81], v[88:89]
    v_pk_mul_f32 v[82:83], v[82:83], v[90:91]
    v_pk_mul_f32 v[84:85], v[84:85], v[92:93]
    v_pk_mul_f32 v[86:87], v[86:87], v[94:95]
    v_pk_add_f32 v[16:17], v[16:17], s[64:65]
    v_pk_add_f32 v[18:19], v[18:19], s[64:65]
    v_pk_add_f32 v[20:21], v[20:21], s[64:65]
    v_pk_add_f32 v[22:23], v[22:23], s[64:65]
    v_rcp_f32 v16, v16
    v_rcp_f32 v17, v17
    v_rcp_f32 v18, v18
    v_rcp_f32 v19, v19
    v_rcp_f32 v20, v20
    v_rcp_f32 v21, v21
    v_rcp_f32 v22, v22
    v_rcp_f32 v23, v23
    s_nop 0
    v_pk_mul_f32 v[80:81], v[80:81], v[16:17]
    v_pk_mul_f32 v[82:83], v[82:83], v[18:19]
    v_pk_mul_f32 v[84:85], v[84:85], v[20:21]
    v_pk_mul_f32 v[86:87], v[86:87], v[22:23]
    v_cvt_pk_bf16_f32 v28, v80, v81
    v_cvt_pk_bf16_f32 v29, v82, v83
    v_cvt_pk_bf16_f32 v30, v84, v85
    v_cvt_pk_bf16_f32 v31, v86, v87
    buffer_store_dwordx4 v[28:31], v2, s[8:11], s81 offen offset:1024 sc1
    v_pk_mul_f32 v[16:17], v[96:97], s[62:63]
    v_pk_mul_f32 v[18:19], v[98:99], s[62:63]
    v_pk_mul_f32 v[20:21], v[100:101], s[62:63]
    v_pk_mul_f32 v[22:23], v[102:103], s[62:63]
    v_exp_f32 v16, v16
    v_exp_f32 v17, v17
    v_exp_f32 v18, v18
    v_exp_f32 v19, v19
    v_exp_f32 v20, v20
    v_exp_f32 v21, v21
    v_exp_f32 v22, v22
    v_exp_f32 v23, v23
    v_pk_mul_f32 v[96:97], v[96:97], v[104:105]
    v_pk_mul_f32 v[98:99], v[98:99], v[106:107]
    v_pk_mul_f32 v[100:101], v[100:101], v[108:109]
    v_pk_mul_f32 v[102:103], v[102:103], v[110:111]
    v_pk_add_f32 v[16:17], v[16:17], s[64:65]
    v_pk_add_f32 v[18:19], v[18:19], s[64:65]
    v_pk_add_f32 v[20:21], v[20:21], s[64:65]
    v_pk_add_f32 v[22:23], v[22:23], s[64:65]
    v_rcp_f32 v16, v16
    v_rcp_f32 v17, v17
    v_rcp_f32 v18, v18
    v_rcp_f32 v19, v19
    v_rcp_f32 v20, v20
    v_rcp_f32 v21, v21
    v_rcp_f32 v22, v22
    v_rcp_f32 v23, v23
    s_nop 0
    v_pk_mul_f32 v[96:97], v[96:97], v[16:17]
    v_pk_mul_f32 v[98:99], v[98:99], v[18:19]
    v_pk_mul_f32 v[100:101], v[100:101], v[20:21]
    v_pk_mul_f32 v[102:103], v[102:103], v[22:23]
    v_cvt_pk_bf16_f32 v24, v96, v97
    v_cvt_pk_bf16_f32 v25, v98, v99
    v_cvt_pk_bf16_f32 v26, v100, v101
    v_cvt_pk_bf16_f32 v27, v102, v103
    buffer_store_dwordx4 v[24:27], v2, s[8:11], s81 offen offset:2048 sc1
    v_add_u32 v16, s76, v2
    s_xor_b32 s50, s44, 1
    s_lshl_b32 s50, s50, 14
    s_add_u32 s50, s50, 65536
    v_add_u32 v17, s50, v2
    s_xor_b32 s50, s44, 2
    s_lshl_b32 s50, s50, 14
    s_add_u32 s50, s50, 69632
    v_add_u32 v18, s50, v2
    s_xor_b32 s50, s44, 3
    s_lshl_b32 s50, s50, 14
    s_add_u32 s50, s50, 73728
    v_add_u32 v19, s50, v2
    v_mov_b32 v15, 18
    v_lshrrev_b32 v20, 5, v1
    v_lshl_add_u32 v20, v20, 3, v43
    v_mov_b32 v21, 18
    v_xor_b32 v22, 0, v33
    v_xor_b32 v23, 16, v33
    v_xor_b32 v24, 32, v33
    v_xor_b32 v25, 48, v33
    ds_read_b64 v[32:33], v22
    ds_read_b64 v[34:35], v23
    ds_read_b64 v[36:37], v24
    ds_read_b64 v[38:39], v25
    s_waitcnt lgkmcnt(0)
    ds_read_b64_tr_b16 v[48:49], v40 offset:0
    ds_read_b64_tr_b16 v[50:51], v40 offset:1024
    ds_read_b64_tr_b16 v[52:53], v41 offset:0
    ds_read_b64_tr_b16 v[54:55], v41 offset:1024
    v_lshlrev_b32 v64, 16, v32
    v_and_b32 v65, s49, v32
    v_lshlrev_b32 v66, 16, v33
    v_and_b32 v67, s49, v33
    v_lshlrev_b32 v68, 16, v34
    v_and_b32 v69, s49, v34
    v_lshlrev_b32 v70, 16, v35
    v_and_b32 v71, s49, v35
    v_lshlrev_b32 v72, 16, v36
    v_and_b32 v73, s49, v36
    v_lshlrev_b32 v74, 16, v37
    v_and_b32 v75, s49, v37
    v_lshlrev_b32 v76, 16, v38
    v_and_b32 v77, s49, v38
    v_lshlrev_b32 v78, 16, v39
    v_and_b32 v79, s49, v39
    s_setprio 0
    ds_read_b64_tr_b16 v[56:57], v40 offset:2048
    ds_read_b64_tr_b16 v[58:59], v40 offset:3072
    ds_read_b64_tr_b16 v[60:61], v41 offset:2048
    ds_read_b64_tr_b16 v[62:63], v41 offset:3072
    s_waitcnt vmcnt(17) lgkmcnt(4)
    v_mfma_f32_32x32x16_bf16 v[64:79], v[48:51], v[128:131], v[64:79]
    v_mfma_f32_32x32x16_bf16 v[80:95], v[52:55], v[128:131], 0
    v_mfma_f32_32x32x16_bf16 v[112:127], v[52:55], v[132:135], 0
    v_mfma_f32_32x32x16_bf16 v[96:111], v[48:51], v[132:135], 0
    s_add_u32 s80, s0, 8
    s_and_b32 s80, s80, 15
    s_add_u32 s80, s80, s60
    s_add_u32 m0, s76, 0
    s_lshl_b32 s50, s80, 14
    s_add_u32 s50, s50, s74
    s_add_u32 s51, s50, 7168
    buffer_load_dwordx4 v7, s[32:35], s50 offen lds
    buffer_load_dwordx4 v7, s[32:35], s51 offen offset:1024 lds
    ds_read_b64_tr_b16 v[48:49], v40 offset:4096
    ds_read_b64_tr_b16 v[50:51], v40 offset:5120
    ds_read_b64_tr_b16 v[52:53], v41 offset:4096
    ds_read_b64_tr_b16 v[54:55], v41 offset:5120
    s_waitcnt vmcnt(17) lgkmcnt(4)
    v_mfma_f32_32x32x16_bf16 v[64:79], v[56:59], v[136:139], v[64:79]
    v_mfma_f32_32x32x16_bf16 v[80:95], v[60:63], v[136:139], v[80:95]
    v_mfma_f32_32x32x16_bf16 v[112:127], v[60:63], v[140:143], v[112:127]
    v_mfma_f32_32x32x16_bf16 v[96:111], v[56:59], v[140:143], v[96:111]
    s_waitcnt vmcnt(2)
    s_mov_b64 exec, 1
    buffer_store_dword v44, v45, s[8:11], s101 offen offset:4 sc1
    s_mov_b64 exec, -1
    s_add_u32 s80, s0, 9
    s_and_b32 s80, s80, 15
    s_add_u32 s80, s80, s60
    s_add_u32 m0, s76, 2048
    s_lshl_b32 s50, s80, 14
    s_add_u32 s50, s50, s74
    s_add_u32 s51, s50, 7168
    buffer_load_dwordx4 v7, s[32:35], s50 offen lds
    buffer_load_dwordx4 v7, s[32:35], s51 offen offset:1024 lds
    ds_read_b64_tr_b16 v[56:57], v40 offset:6144
    ds_read_b64_tr_b16 v[58:59], v40 offset:7168
    ds_read_b64_tr_b16 v[60:61], v41 offset:6144
    ds_read_b64_tr_b16 v[62:63], v41 offset:7168
    s_waitcnt lgkmcnt(4)
    v_mfma_f32_32x32x16_bf16 v[64:79], v[48:51], v[144:147], v[64:79]
    v_mfma_f32_32x32x16_bf16 v[80:95], v[52:55], v[144:147], v[80:95]
    v_mfma_f32_32x32x16_bf16 v[112:127], v[52:55], v[148:151], v[112:127]
    v_mfma_f32_32x32x16_bf16 v[96:111], v[48:51], v[148:151], v[96:111]
    s_add_u32 s80, s0, 10
    s_and_b32 s80, s80, 15
    s_add_u32 s80, s80, s60
    s_add_u32 m0, s76, 4096
    s_lshl_b32 s50, s80, 14
    s_add_u32 s50, s50, s74
    s_add_u32 s51, s50, 7168
    buffer_load_dwordx4 v7, s[32:35], s50 offen lds
    buffer_load_dwordx4 v7, s[32:35], s51 offen offset:1024 lds
    ds_read_b64_tr_b16 v[48:49], v40 offset:8192
    ds_read_b64_tr_b16 v[50:51], v40 offset:9216
    ds_read_b64_tr_b16 v[52:53], v41 offset:8192
    ds_read_b64_tr_b16 v[54:55], v41 offset:9216
    s_waitcnt lgkmcnt(4)
    v_mfma_f32_32x32x16_bf16 v[64:79], v[56:59], v[152:155], v[64:79]
    v_mfma_f32_32x32x16_bf16 v[80:95], v[60:63], v[152:155], v[80:95]
    v_mfma_f32_32x32x16_bf16 v[112:127], v[60:63], v[156:159], v[112:127]
    v_mfma_f32_32x32x16_bf16 v[96:111], v[56:59], v[156:159], v[96:111]
    s_add_u32 s80, s0, 11
    s_and_b32 s80, s80, 15
    s_add_u32 s80, s80, s60
    s_add_u32 m0, s76, 6144
    s_lshl_b32 s50, s80, 14
    s_add_u32 s50, s50, s74
    s_add_u32 s51, s50, 7168
    buffer_load_dwordx4 v7, s[32:35], s50 offen lds
    buffer_load_dwordx4 v7, s[32:35], s51 offen offset:1024 lds
    ds_read_b64_tr_b16 v[56:57], v40 offset:10240
    ds_read_b64_tr_b16 v[58:59], v40 offset:11264
    ds_read_b64_tr_b16 v[60:61], v41 offset:10240
    ds_read_b64_tr_b16 v[62:63], v41 offset:11264
    s_waitcnt lgkmcnt(4)
    v_mfma_f32_32x32x16_bf16 v[64:79], v[48:51], v[160:163], v[64:79]
    v_mfma_f32_32x32x16_bf16 v[80:95], v[52:55], v[160:163], v[80:95]
    v_mfma_f32_32x32x16_bf16 v[112:127], v[52:55], v[164:167], v[112:127]
    v_mfma_f32_32x32x16_bf16 v[96:111], v[48:51], v[164:167], v[96:111]
    s_add_u32 s80, s0, 12
    s_and_b32 s80, s80, 15
    s_add_u32 s80, s80, s60
    s_add_u32 m0, s76, 8192
    s_lshl_b32 s50, s80, 14
    s_add_u32 s50, s50, s74
    s_add_u32 s51, s50, 7168
    buffer_load_dwordx4 v7, s[32:35], s50 offen lds
    buffer_load_dwordx4 v7, s[32:35], s51 offen offset:1024 lds
    ds_read_b64_tr_b16 v[48:49], v40 offset:12288
    ds_read_b64_tr_b16 v[50:51], v40 offset:13312
    ds_read_b64_tr_b16 v[52:53], v41 offset:12288
    ds_read_b64_tr_b16 v[54:55], v41 offset:13312
    s_waitcnt lgkmcnt(4)
    v_mfma_f32_32x32x16_bf16 v[64:79], v[56:59], v[168:171], v[64:79]
    v_mfma_f32_32x32x16_bf16 v[80:95], v[60:63], v[168:171], v[80:95]
    v_mfma_f32_32x32x16_bf16 v[112:127], v[60:63], v[172:175], v[112:127]
    v_mfma_f32_32x32x16_bf16 v[96:111], v[56:59], v[172:175], v[96:111]
    s_add_u32 s80, s0, 8
    s_and_b32 s80, s80, 15
    s_add_u32 s80, s80, s60
    s_lshl_b32 s50, s80, 10
    s_add_u32 s51, s50, s70
    buffer_load_dwordx4 v[192:195], v2, s[8:11], s51 offen sc1
    s_add_u32 s51, s50, s71
    buffer_load_dwordx4 v[196:199], v2, s[8:11], s51 offen sc1
    s_add_u32 s80, s0, 13
    s_and_b32 s80, s80, 15
    s_add_u32 s80, s80, s60
    s_add_u32 m0, s76, 10240
    s_lshl_b32 s50, s80, 14
    s_add_u32 s50, s50, s74
    s_add_u32 s51, s50, 7168
    buffer_load_dwordx4 v7, s[32:35], s50 offen lds
    buffer_load_dwordx4 v7, s[32:35], s51 offen offset:1024 lds
    ds_read_b64_tr_b16 v[56:57], v40 offset:14336
    ds_read_b64_tr_b16 v[58:59], v40 offset:15360
    ds_read_b64_tr_b16 v[60:61], v41 offset:14336
    ds_read_b64_tr_b16 v[62:63], v41 offset:15360
    s_waitcnt lgkmcnt(4)
    v_mfma_f32_32x32x16_bf16 v[64:79], v[48:51], v[176:179], v[64:79]
    v_mfma_f32_32x32x16_bf16 v[80:95], v[52:55], v[176:179], v[80:95]
    v_mfma_f32_32x32x16_bf16 v[112:127], v[52:55], v[180:183], v[112:127]
    v_mfma_f32_32x32x16_bf16 v[96:111], v[48:51], v[180:183], v[96:111]
    s_add_u32 s80, s0, 9
    s_and_b32 s80, s80, 15
    s_add_u32 s80, s80, s60
    s_lshl_b32 s50, s80, 10
    s_add_u32 s51, s50, s70
    buffer_load_dwordx4 v[200:203], v2, s[8:11], s51 offen sc1
    s_add_u32 s51, s50, s71
    buffer_load_dwordx4 v[204:207], v2, s[8:11], s51 offen sc1
    s_add_u32 s80, s0, 14
    s_and_b32 s80, s80, 15
    s_add_u32 s80, s80, s60
    s_add_u32 m0, s76, 12288
    s_lshl_b32 s50, s80, 14
    s_add_u32 s50, s50, s74
    s_add_u32 s51, s50, 7168
    buffer_load_dwordx4 v7, s[32:35], s50 offen lds
    buffer_load_dwordx4 v7, s[32:35], s51 offen offset:1024 lds
    s_waitcnt vmcnt(17)
    ds_read_b64_tr_b16 v[48:49], v40 offset:0
    ds_read_b64_tr_b16 v[50:51], v40 offset:1024
    ds_read_b64_tr_b16 v[52:53], v41 offset:0
    ds_read_b64_tr_b16 v[54:55], v41 offset:1024
    s_waitcnt lgkmcnt(4)
    v_mfma_f32_32x32x16_bf16 v[64:79], v[56:59], v[184:187], v[64:79]
    v_mfma_f32_32x32x16_bf16 v[80:95], v[60:63], v[184:187], v[80:95]
    v_mfma_f32_32x32x16_bf16 v[112:127], v[60:63], v[188:191], v[112:127]
    v_mfma_f32_32x32x16_bf16 v[96:111], v[56:59], v[188:191], v[96:111]
    s_add_u32 s80, s0, 10
    s_and_b32 s80, s80, 15
    s_add_u32 s80, s80, s60
    s_lshl_b32 s50, s80, 10
    s_add_u32 s51, s50, s70
    buffer_load_dwordx4 v[208:211], v2, s[8:11], s51 offen sc1
    s_add_u32 s51, s50, s71
    buffer_load_dwordx4 v[212:215], v2, s[8:11], s51 offen sc1
    s_add_u32 s80, s0, 15
    s_and_b32 s80, s80, 15
    s_add_u32 s80, s80, s60
    s_add_u32 m0, s76, 14336
    s_lshl_b32 s50, s80, 14
    s_add_u32 s50, s50, s74
    s_add_u32 s51, s50, 7168
    buffer_load_dwordx4 v7, s[32:35], s50 offen lds
    buffer_load_dwordx4 v7, s[32:35], s51 offen offset:1024 lds
    s_waitcnt vmcnt(18)
    ds_read_b64_tr_b16 v[56:57], v40 offset:2048
    ds_read_b64_tr_b16 v[58:59], v40 offset:3072
    ds_read_b64_tr_b16 v[60:61], v41 offset:2048
    ds_read_b64_tr_b16 v[62:63], v41 offset:3072
    s_waitcnt vmcnt(10) lgkmcnt(4)
    v_mfma_f32_32x32x16_bf16 v[64:79], v[48:51], v[192:195], v[64:79]
    v_mfma_f32_32x32x16_bf16 v[80:95], v[52:55], v[192:195], v[80:95]
    v_mfma_f32_32x32x16_bf16 v[112:127], v[52:55], v[196:199], v[112:127]
    v_mfma_f32_32x32x16_bf16 v[96:111], v[48:51], v[196:199], v[96:111]
    s_add_u32 s80, s0, 11
    s_and_b32 s80, s80, 15
    s_add_u32 s80, s80, s60
    s_lshl_b32 s50, s80, 10
    s_add_u32 s51, s50, s70
    buffer_load_dwordx4 v[216:219], v2, s[8:11], s51 offen sc1
    s_add_u32 s51, s50, s71
    buffer_load_dwordx4 v[220:223], v2, s[8:11], s51 offen sc1
    s_add_u32 s80, s1, 0
    s_sub_u32 s52, s80, 12
    s_cmp_ge_u32 s80, 12
    s_cselect_b32 s80, s52, s80
    s_add_u32 s80, s80, s61
    s_add_u32 m0, s76, 0
    s_lshl_b32 s50, s80, 14
    s_add_u32 s50, s50, s74
    s_add_u32 s51, s50, 7168
    buffer_load_dwordx4 v7, s[32:35], s50 offen lds
    buffer_load_dwordx4 v7, s[32:35], s51 offen offset:1024 lds
    ds_read_b64_tr_b16 v[48:49], v40 offset:4096
    ds_read_b64_tr_b16 v[50:51], v40 offset:5120
    ds_read_b64_tr_b16 v[52:53], v41 offset:4096
    ds_read_b64_tr_b16 v[54:55], v41 offset:5120
    s_waitcnt vmcnt(10) lgkmcnt(4)
    v_mfma_f32_32x32x16_bf16 v[64:79], v[56:59], v[200:203], v[64:79]
    v_mfma_f32_32x32x16_bf16 v[80:95], v[60:63], v[200:203], v[80:95]
    v_mfma_f32_32x32x16_bf16 v[112:127], v[60:63], v[204:207], v[112:127]
    v_mfma_f32_32x32x16_bf16 v[96:111], v[56:59], v[204:207], v[96:111]
    s_add_u32 s80, s0, 12
    s_and_b32 s80, s80, 15
    s_add_u32 s80, s80, s60
    s_lshl_b32 s50, s80, 10
    s_add_u32 s51, s50, s70
    buffer_load_dwordx4 v[224:227], v2, s[8:11], s51 offen sc1
    s_add_u32 s51, s50, s71
    buffer_load_dwordx4 v[228:231], v2, s[8:11], s51 offen sc1
    s_add_u32 s80, s1, 1
    s_sub_u32 s52, s80, 12
    s_cmp_ge_u32 s80, 12
    s_cselect_b32 s80, s52, s80
    s_add_u32 s80, s80, s61
    s_add_u32 m0, s76, 2048
    s_lshl_b32 s50, s80, 14
    s_add_u32 s50, s50, s74
    s_add_u32 s51, s50, 7168
    buffer_load_dwordx4 v7, s[32:35], s50 offen lds
    buffer_load_dwordx4 v7, s[32:35], s51 offen offset:1024 lds
    ds_read_b64_tr_b16 v[56:57], v40 offset:6144
    ds_read_b64_tr_b16 v[58:59], v40 offset:7168
    ds_read_b64_tr_b16 v[60:61], v41 offset:6144
    ds_read_b64_tr_b16 v[62:63], v41 offset:7168
    s_waitcnt vmcnt(10) lgkmcnt(4)
    v_mfma_f32_32x32x16_bf16 v[64:79], v[48:51], v[208:211], v[64:79]
    v_mfma_f32_32x32x16_bf16 v[80:95], v[52:55], v[208:211], v[80:95]
    v_mfma_f32_32x32x16_bf16 v[112:127], v[52:55], v[212:215], v[112:127]
    v_mfma_f32_32x32x16_bf16 v[96:111], v[48:51], v[212:215], v[96:111]
    s_mov_b32 s53, 65536
    s_mov_b64 exec, 0xff
    buffer_load_dwordx2 v[46:47], v42, s[8:11], s53 offen sc1
    s_mov_b64 exec, -1
    s_add_u32 s80, s0, 13
    s_and_b32 s80, s80, 15
    s_add_u32 s80, s80, s60
    s_lshl_b32 s50, s80, 10
    s_add_u32 s51, s50, s70
    buffer_load_dwordx4 v[232:235], v2, s[8:11], s51 offen sc1
    s_add_u32 s51, s50, s71
    buffer_load_dwordx4 v[236:239], v2, s[8:11], s51 offen sc1
    s_add_u32 s80, s1, 2
    s_sub_u32 s52, s80, 12
    s_cmp_ge_u32 s80, 12
    s_cselect_b32 s80, s52, s80
    s_add_u32 s80, s80, s61
    s_add_u32 m0, s76, 4096
    s_lshl_b32 s50, s80, 14
    s_add_u32 s50, s50, s74
    s_add_u32 s51, s50, 7168
    buffer_load_dwordx4 v7, s[32:35], s50 offen lds
    buffer_load_dwordx4 v7, s[32:35], s51 offen offset:1024 lds
    ds_read_b64_tr_b16 v[48:49], v40 offset:8192
    ds_read_b64_tr_b16 v[50:51], v40 offset:9216
    ds_read_b64_tr_b16 v[52:53], v41 offset:8192
    ds_read_b64_tr_b16 v[54:55], v41 offset:9216
    s_waitcnt vmcnt(11) lgkmcnt(4)
    v_mfma_f32_32x32x16_bf16 v[64:79], v[56:59], v[216:219], v[64:79]
    v_mfma_f32_32x32x16_bf16 v[80:95], v[60:63], v[216:219], v[80:95]
    v_mfma_f32_32x32x16_bf16 v[112:127], v[60:63], v[220:223], v[112:127]
    v_mfma_f32_32x32x16_bf16 v[96:111], v[56:59], v[220:223], v[96:111]
    s_add_u32 s80, s0, 14
    s_and_b32 s80, s80, 15
    s_add_u32 s80, s80, s60
    s_lshl_b32 s50, s80, 10
    s_add_u32 s51, s50, s70
    buffer_load_dwordx4 v[240:243], v2, s[8:11], s51 offen sc1
    s_add_u32 s51, s50, s71
    buffer_load_dwordx4 v[244:247], v2, s[8:11], s51 offen sc1
    s_add_u32 s80, s1, 3
    s_sub_u32 s52, s80, 12
    s_cmp_ge_u32 s80, 12
    s_cselect_b32 s80, s52, s80
    s_add_u32 s80, s80, s61
    s_add_u32 m0, s76, 6144
    s_lshl_b32 s50, s80, 14
    s_add_u32 s50, s50, s74
    s_add_u32 s51, s50, 7168
    buffer_load_dwordx4 v7, s[32:35], s50 offen lds
    buffer_load_dwordx4 v7, s[32:35], s51 offen offset:1024 lds
    ds_read_b64_tr_b16 v[56:57], v40 offset:10240
    ds_read_b64_tr_b16 v[58:59], v40 offset:11264
    ds_read_b64_tr_b16 v[60:61], v41 offset:10240
    ds_read_b64_tr_b16 v[62:63], v41 offset:11264
    s_waitcnt vmcnt(11) lgkmcnt(4)
    v_mfma_f32_32x32x16_bf16 v[64:79], v[48:51], v[224:227], v[64:79]
    v_mfma_f32_32x32x16_bf16 v[80:95], v[52:55], v[224:227], v[80:95]
    v_mfma_f32_32x32x16_bf16 v[112:127], v[52:55], v[228:231], v[112:127]
    v_mfma_f32_32x32x16_bf16 v[96:111], v[48:51], v[228:231], v[96:111]
    s_add_u32 s80, s0, 15
    s_and_b32 s80, s80, 15
    s_add_u32 s80, s80, s60
    s_lshl_b32 s50, s80, 10
    s_add_u32 s51, s50, s70
    buffer_load_dwordx4 v[248:251], v2, s[8:11], s51 offen sc1
    s_add_u32 s51, s50, s71
    buffer_load_dwordx4 v[252:255], v2, s[8:11], s51 offen sc1
    s_add_u32 s80, s1, 4
    s_sub_u32 s52, s80, 12
    s_cmp_ge_u32 s80, 12
    s_cselect_b32 s80, s52, s80
    s_add_u32 s80, s80, s61
    s_add_u32 m0, s76, 8192
    s_lshl_b32 s50, s80, 14
    s_add_u32 s50, s50, s74
    s_add_u32 s51, s50, 7168
    buffer_load_dwordx4 v7, s[32:35], s50 offen lds
    buffer_load_dwordx4 v7, s[32:35], s51 offen offset:1024 lds
    ds_read_b64_tr_b16 v[48:49], v40 offset:12288
    ds_read_b64_tr_b16 v[50:51], v40 offset:13312
    ds_read_b64_tr_b16 v[52:53], v41 offset:12288
    ds_read_b64_tr_b16 v[54:55], v41 offset:13312
    s_waitcnt vmcnt(10) lgkmcnt(4)
    v_mfma_f32_32x32x16_bf16 v[64:79], v[56:59], v[232:235], v[64:79]
    v_mfma_f32_32x32x16_bf16 v[80:95], v[60:63], v[232:235], v[80:95]
    v_mfma_f32_32x32x16_bf16 v[112:127], v[60:63], v[236:239], v[112:127]
    v_mfma_f32_32x32x16_bf16 v[96:111], v[56:59], v[236:239], v[96:111]
    s_setprio 2
    s_mov_b32 s56, 0
    s_mov_b64 exec, 0xff
    v_cmp_ne_u32 vcc, s48, v47
    s_cbranch_vccz L_pollx_73
L_poll_72:
    buffer_load_dwordx2 v[46:47], v42, s[8:11], s53 offen sc1
    s_add_u32 s56, s56, 1
    s_waitcnt vmcnt(0)
    v_cmp_ne_u32 vcc, s48, v47
    s_cmp_gt_u32 s56, 200000
    s_cbranch_scc1 L_pollx_73
    s_cbranch_vccnz L_poll_72
L_pollx_73:
    s_mov_b64 exec, -1
    s_setprio 0
    s_add_u32 s80, s1, 0
    s_sub_u32 s52, s80, 12
    s_cmp_ge_u32 s80, 12
    s_cselect_b32 s80, s52, s80
    s_add_u32 s80, s80, s61
    s_lshl_b32 s50, s80, 10
    s_add_u32 s51, s50, s70
    buffer_load_dwordx4 v[128:131], v2, s[8:11], s51 offen sc1
    s_add_u32 s51, s50, s71
    buffer_load_dwordx4 v[132:135], v2, s[8:11], s51 offen sc1
    s_add_u32 s80, s1, 5
    s_sub_u32 s52, s80, 12
    s_cmp_ge_u32 s80, 12
    s_cselect_b32 s80, s52, s80
    s_add_u32 s80, s80, s61
    s_add_u32 m0, s76, 10240
    s_lshl_b32 s50, s80, 14
    s_add_u32 s50, s50, s74
    s_add_u32 s51, s50, 7168
    buffer_load_dwordx4 v7, s[32:35], s50 offen lds
    buffer_load_dwordx4 v7, s[32:35], s51 offen offset:1024 lds
    ds_read_b64_tr_b16 v[56:57], v40 offset:14336
    ds_read_b64_tr_b16 v[58:59], v40 offset:15360
    ds_read_b64_tr_b16 v[60:61], v41 offset:14336
    ds_read_b64_tr_b16 v[62:63], v41 offset:15360
    s_waitcnt vmcnt(10) lgkmcnt(4)
    v_mfma_f32_32x32x16_bf16 v[64:79], v[48:51], v[240:243], v[64:79]
    v_mfma_f32_32x32x16_bf16 v[80:95], v[52:55], v[240:243], v[80:95]
    v_mfma_f32_32x32x16_bf16 v[112:127], v[52:55], v[244:247], v[112:127]
    v_mfma_f32_32x32x16_bf16 v[96:111], v[48:51], v[244:247], v[96:111]
    s_add_u32 s80, s1, 1
    s_sub_u32 s52, s80, 12
    s_cmp_ge_u32 s80, 12
    s_cselect_b32 s80, s52, s80
    s_add_u32 s80, s80, s61
    s_lshl_b32 s50, s80, 10
    s_add_u32 s51, s50, s70
    buffer_load_dwordx4 v[136:139], v2, s[8:11], s51 offen sc1
    s_add_u32 s51, s50, s71
    buffer_load_dwordx4 v[140:143], v2, s[8:11], s51 offen sc1
    s_add_u32 s80, s1, 6
    s_sub_u32 s52, s80, 12
    s_cmp_ge_u32 s80, 12
    s_cselect_b32 s80, s52, s80
    s_add_u32 s80, s80, s61
    s_add_u32 m0, s76, 12288
    s_lshl_b32 s50, s80, 14
    s_add_u32 s50, s50, s74
    s_add_u32 s51, s50, 7168
    buffer_load_dwordx4 v7, s[32:35], s50 offen lds
    buffer_load_dwordx4 v7, s[32:35], s51 offen offset:1024 lds
    ds_read_b64_tr_b16 v[48:49], v40 offset:0
    ds_read_b64_tr_b16 v[50:51], v40 offset:1024
    ds_read_b64_tr_b16 v[52:53], v41 offset:0
    ds_read_b64_tr_b16 v[54:55], v41 offset:1024
    s_waitcnt vmcnt(10) lgkmcnt(4)
    v_mfma_f32_32x32x16_bf16 v[64:79], v[56:59], v[248:251], v[64:79]
    v_mfma_f32_32x32x16_bf16 v[80:95], v[60:63], v[248:251], v[80:95]
    v_mfma_f32_32x32x16_bf16 v[112:127], v[60:63], v[252:255], v[112:127]
    v_mfma_f32_32x32x16_bf16 v[96:111], v[56:59], v[252:255], v[96:111]
    s_add_u32 s80, s1, 2
    s_sub_u32 s52, s80, 12
    s_cmp_ge_u32 s80, 12
    s_cselect_b32 s80, s52, s80
    s_add_u32 s80, s80, s61
    s_lshl_b32 s50, s80, 10
    s_add_u32 s51, s50, s70
    buffer_load_dwordx4 v[144:147], v2, s[8:11], s51 offen sc1
    s_add_u32 s51, s50, s71
    buffer_load_dwordx4 v[148:151], v2, s[8:11], s51 offen sc1
    s_add_u32 s80, s1, 7
    s_sub_u32 s52, s80, 12
    s_cmp_ge_u32 s80, 12
    s_cselect_b32 s80, s52, s80
    s_add_u32 s80, s80, s61
    s_add_u32 m0, s76, 14336
    s_lshl_b32 s50, s80, 14
    s_add_u32 s50, s50, s74
    s_add_u32 s51, s50, 7168
    buffer_load_dwordx4 v7, s[32:35], s50 offen lds
    buffer_load_dwordx4 v7, s[32:35], s51 offen offset:1024 lds
    ds_read_b64_tr_b16 v[56:57], v40 offset:2048
    ds_read_b64_tr_b16 v[58:59], v40 offset:3072
    ds_read_b64_tr_b16 v[60:61], v41 offset:2048
    ds_read_b64_tr_b16 v[62:63], v41 offset:3072
    s_waitcnt vmcnt(10) lgkmcnt(4)
    v_mfma_f32_32x32x16_bf16 v[64:79], v[48:51], v[128:131], v[64:79]
    v_mfma_f32_32x32x16_bf16 v[80:95], v[52:55], v[128:131], v[80:95]
    v_mfma_f32_32x32x16_bf16 v[112:127], v[52:55], v[132:135], v[112:127]
    v_mfma_f32_32x32x16_bf16 v[96:111], v[48:51], v[132:135], v[96:111]
    s_add_u32 s80, s1, 3
    s_sub_u32 s52, s80, 12
    s_cmp_ge_u32 s80, 12
    s_cselect_b32 s80, s52, s80
    s_add_u32 s80, s80, s61
    s_lshl_b32 s50, s80, 10
    s_add_u32 s51, s50, s70
    buffer_load_dwordx4 v[152:155], v2, s[8:11], s51 offen sc1
    s_add_u32 s51, s50, s71
    buffer_load_dwordx4 v[156:159], v2, s[8:11], s51 offen sc1
    s_add_u32 s80, s1, 8
    s_sub_u32 s52, s80, 12
    s_cmp_ge_u32 s80, 12
    s_cselect_b32 s80, s52, s80
    s_add_u32 s80, s80, s61
    s_add_u32 m0, s76, 0
    s_lshl_b32 s50, s80, 14
    s_add_u32 s50, s50, s74
    s_add_u32 s51, s50, 7168
    buffer_load_dwordx4 v7, s[32:35], s50 offen lds
    buffer_load_dwordx4 v7, s[32:35], s51 offen offset:1024 lds
    ds_read_b64_tr_b16 v[48:49], v40 offset:4096
    ds_read_b64_tr_b16 v[50:51], v40 offset:5120
    ds_read_b64_tr_b16 v[52:53], v41 offset:4096
    ds_read_b64_tr_b16 v[54:55], v41 offset:5120
    s_waitcnt vmcnt(10) lgkmcnt(4)
    v_mfma_f32_32x32x16_bf16 v[64:79], v[56:59], v[136:139], v[64:79]
    v_mfma_f32_32x32x16_bf16 v[80:95], v[60:63], v[136:139], v[80:95]
    v_mfma_f32_32x32x16_bf16 v[112:127], v[60:63], v[140:143], v[112:127]
    v_mfma_f32_32x32x16_bf16 v[96:111], v[56:59], v[140:143], v[96:111]
    s_add_u32 s80, s1, 4
    s_sub_u32 s52, s80, 12
    s_cmp_ge_u32 s80, 12
    s_cselect_b32 s80, s52, s80
    s_add_u32 s80, s80, s61
    s_lshl_b32 s50, s80, 10
    s_add_u32 s51, s50, s70
    buffer_load_dwordx4 v[160:163], v2, s[8:11], s51 offen sc1
    s_add_u32 s51, s50, s71
    buffer_load_dwordx4 v[164:167], v2, s[8:11], s51 offen sc1
    s_add_u32 s80, s1, 9
    s_sub_u32 s52, s80, 12
    s_cmp_ge_u32 s80, 12
    s_cselect_b32 s80, s52, s80
    s_add_u32 s80, s80, s61
    s_add_u32 m0, s76, 2048
    s_lshl_b32 s50, s80, 14
    s_add_u32 s50, s50, s74
    s_add_u32 s51, s50, 7168
    buffer_load_dwordx4 v7, s[32:35], s50 offen lds
    buffer_load_dwordx4 v7, s[32:35], s51 offen offset:1024 lds
    ds_read_b64_tr_b16 v[56:57], v40 offset:6144
    ds_read_b64_tr_b16 v[58:59], v40 offset:7168
    ds_read_b64_tr_b16 v[60:61], v41 offset:6144
    ds_read_b64_tr_b16 v[62:63], v41 offset:7168
    s_waitcnt vmcnt(10) lgkmcnt(4)
    v_mfma_f32_32x32x16_bf16 v[64:79], v[48:51], v[144:147], v[64:79]
    v_mfma_f32_32x32x16_bf16 v[80:95], v[52:55], v[144:147], v[80:95]
    v_mfma_f32_32x32x16_bf16 v[112:127], v[52:55], v[148:151], v[112:127]
    v_mfma_f32_32x32x16_bf16 v[96:111], v[48:51], v[148:151], v[96:111]
    s_add_u32 s80, s1, 5
    s_sub_u32 s52, s80, 12
    s_cmp_ge_u32 s80, 12
    s_cselect_b32 s80, s52, s80
    s_add_u32 s80, s80, s61
    s_lshl_b32 s50, s80, 10
    s_add_u32 s51, s50, s70
    buffer_load_dwordx4 v[168:171], v2, s[8:11], s51 offen sc1
    s_add_u32 s51, s50, s71
    buffer_load_dwordx4 v[172:175], v2, s[8:11], s51 offen sc1
    s_add_u32 s80, s1, 10
    s_sub_u32 s52, s80, 12
    s_cmp_ge_u32 s80, 12
    s_cselect_b32 s80, s52, s80
    s_add_u32 s80, s80, s61
    s_add_u32 m0, s76, 4096
    s_lshl_b32 s50, s80, 14
    s_add_u32 s50, s50, s74
    s_add_u32 s51, s50, 7168
    buffer_load_dwordx4 v7, s[32:35], s50 offen lds
    buffer_load_dwordx4 v7, s[32:35], s51 offen offset:1024 lds
    ds_read_b64_tr_b16 v[48:49], v40 offset:8192
    ds_read_b64_tr_b16 v[50:51], v40 offset:9216
    ds_read_b64_tr_b16 v[52:53], v41 offset:8192
    ds_read_b64_tr_b16 v[54:55], v41 offset:9216
    s_waitcnt vmcnt(10) lgkmcnt(4)
    v_mfma_f32_32x32x16_bf16 v[64:79], v[56:59], v[152:155], v[64:79]
    v_mfma_f32_32x32x16_bf16 v[80:95], v[60:63], v[152:155], v[80:95]
    v_mfma_f32_32x32x16_bf16 v[112:127], v[60:63], v[156:159], v[112:127]
    v_mfma_f32_32x32x16_bf16 v[96:111], v[56:59], v[156:159], v[96:111]
    s_add_u32 s80, s1, 6
    s_sub_u32 s52, s80, 12
    s_cmp_ge_u32 s80, 12
    s_cselect_b32 s80, s52, s80
    s_add_u32 s80, s80, s61
    s_lshl_b32 s50, s80, 10
    s_add_u32 s51, s50, s70
    buffer_load_dwordx4 v[176:179], v2, s[8:11], s51 offen sc1
    s_add_u32 s51, s50, s71
    buffer_load_dwordx4 v[180:183], v2, s[8:11], s51 offen sc1
    s_add_u32 s80, s1, 11
    s_sub_u32 s52, s80, 12
    s_cmp_ge_u32 s80, 12
    s_cselect_b32 s80, s52, s80
    s_add_u32 s80, s80, s61
    s_add_u32 m0, s76, 6144
    s_lshl_b32 s50, s80, 14
    s_add_u32 s50, s50, s74
    s_add_u32 s51, s50, 7168
    buffer_load_dwordx4 v7, s[32:35], s50 offen lds
    buffer_load_dwordx4 v7, s[32:35], s51 offen offset:1024 lds
    ds_read_b64_tr_b16 v[56:57], v40 offset:10240
    ds_read_b64_tr_b16 v[58:59], v40 offset:11264
    ds_read_b64_tr_b16 v[60:61], v41 offset:10240
    ds_read_b64_tr_b16 v[62:63], v41 offset:11264
    s_waitcnt vmcnt(10) lgkmcnt(4)
    v_mfma_f32_32x32x16_bf16 v[64:79], v[48:51], v[160:163], v[64:79]
    v_mfma_f32_32x32x16_bf16 v[80:95], v[52:55], v[160:163], v[80:95]
    v_mfma_f32_32x32x16_bf16 v[112:127], v[52:55], v[164:167], v[112:127]
    v_mfma_f32_32x32x16_bf16 v[96:111], v[48:51], v[164:167], v[96:111]
    s_add_u32 s80, s1, 7
    s_sub_u32 s52, s80, 12
    s_cmp_ge_u32 s80, 12
    s_cselect_b32 s80, s52, s80
    s_add_u32 s80, s80, s61
    s_lshl_b32 s50, s80, 10
    s_add_u32 s51, s50, s70
    buffer_load_dwordx4 v[184:187], v2, s[8:11], s51 offen sc1
    s_add_u32 s51, s50, s71
    buffer_load_dwordx4 v[188:191], v2, s[8:11], s51 offen sc1
    s_add_u32 s80, s2, 0
    s_and_b32 s80, s80, 7
    s_add_u32 m0, s76, 8192
    s_lshl_b32 s50, s80, 14
    s_add_u32 s50, s50, s75
    s_add_u32 s51, s50, 7168
    buffer_load_dwordx4 v7, s[36:39], s50 offen lds
    buffer_load_dwordx4 v7, s[36:39], s51 offen offset:1024 lds
    ds_read_b64_tr_b16 v[48:49], v40 offset:12288
    ds_read_b64_tr_b16 v[50:51], v40 offset:13312
    ds_read_b64_tr_b16 v[52:53], v41 offset:12288
    ds_read_b64_tr_b16 v[54:55], v41 offset:13312
    s_waitcnt vmcnt(10) lgkmcnt(4)
    v_mfma_f32_32x32x16_bf16 v[64:79], v[56:59], v[168:171], v[64:79]
    v_mfma_f32_32x32x16_bf16 v[80:95], v[60:63], v[168:171], v[80:95]
    v_mfma_f32_32x32x16_bf16 v[112:127], v[60:63], v[172:175], v[112:127]
    v_mfma_f32_32x32x16_bf16 v[96:111], v[56:59], v[172:175], v[96:111]
    s_add_u32 s80, s1, 8
    s_sub_u32 s52, s80, 12
    s_cmp_ge_u32 s80, 12
    s_cselect_b32 s80, s52, s80
    s_add_u32 s80, s80, s61
    s_lshl_b32 s50, s80, 10
    s_add_u32 s51, s50, s70
    buffer_load_dwordx4 v[192:195], v2, s[8:11], s51 offen sc1
    s_add_u32 s51, s50, s71
    buffer_load_dwordx4 v[196:199], v2, s[8:11], s51 offen sc1
    s_add_u32 s80, s2, 1
    s_and_b32 s80, s80, 7
    s_add_u32 m0, s76, 10240
    s_lshl_b32 s50, s80, 14
    s_add_u32 s50, s50, s75
    s_add_u32 s51, s50, 7168
    buffer_load_dwordx4 v7, s[36:39], s50 offen lds
    buffer_load_dwordx4 v7, s[36:39], s51 offen offset:1024 lds
    ds_read_b64_tr_b16 v[56:57], v40 offset:14336
    ds_read_b64_tr_b16 v[58:59], v40 offset:15360
    ds_read_b64_tr_b16 v[60:61], v41 offset:14336
    ds_read_b64_tr_b16 v[62:63], v41 offset:15360
    s_waitcnt vmcnt(10) lgkmcnt(4)
    v_mfma_f32_32x32x16_bf16 v[64:79], v[48:51], v[176:179], v[64:79]
    v_mfma_f32_32x32x16_bf16 v[80:95], v[52:55], v[176:179], v[80:95]
    v_mfma_f32_32x32x16_bf16 v[112:127], v[52:55], v[180:183], v[112:127]
    v_mfma_f32_32x32x16_bf16 v[96:111], v[48:51], v[180:183], v[96:111]
    s_add_u32 s80, s1, 9
    s_sub_u32 s52, s80, 12
    s_cmp_ge_u32 s80, 12
    s_cselect_b32 s80, s52, s80
    s_add_u32 s80, s80, s61
    s_lshl_b32 s50, s80, 10
    s_add_u32 s51, s50, s70
    buffer_load_dwordx4 v[200:203], v2, s[8:11], s51 offen sc1
    s_add_u32 s51, s50, s71
    buffer_load_dwordx4 v[204:207], v2, s[8:11], s51 offen sc1
    s_add_u32 s80, s2, 2
    s_and_b32 s80, s80, 7
    s_add_u32 m0, s76, 12288
    s_lshl_b32 s50, s80, 14
    s_add_u32 s50, s50, s75
    s_add_u32 s51, s50, 7168
    buffer_load_dwordx4 v7, s[36:39], s50 offen lds
    buffer_load_dwordx4 v7, s[36:39], s51 offen offset:1024 lds
    ds_read_b64_tr_b16 v[48:49], v40 offset:0
    ds_read_b64_tr_b16 v[50:51], v40 offset:1024
    ds_read_b64_tr_b16 v[52:53], v41 offset:0
    ds_read_b64_tr_b16 v[54:55], v41 offset:1024
    s_waitcnt vmcnt(10) lgkmcnt(4)
    v_mfma_f32_32x32x16_bf16 v[64:79], v[56:59], v[184:187], v[64:79]
    v_mfma_f32_32x32x16_bf16 v[80:95], v[60:63], v[184:187], v[80:95]
    v_mfma_f32_32x32x16_bf16 v[112:127], v[60:63], v[188:191], v[112:127]
    v_mfma_f32_32x32x16_bf16 v[96:111], v[56:59], v[188:191], v[96:111]
    s_add_u32 s80, s1, 10
    s_sub_u32 s52, s80, 12
    s_cmp_ge_u32 s80, 12
    s_cselect_b32 s80, s52, s80
    s_add_u32 s80, s80, s61
    s_lshl_b32 s50, s80, 10
    s_add_u32 s51, s50, s70
    buffer_load_dwordx4 v[208:211], v2, s[8:11], s51 offen sc1
    s_add_u32 s51, s50, s71
    buffer_load_dwordx4 v[212:215], v2, s[8:11], s51 offen sc1
    s_add_u32 s80, s2, 3
    s_and_b32 s80, s80, 7
    s_add_u32 m0, s76, 14336
    s_lshl_b32 s50, s80, 14
    s_add_u32 s50, s50, s75
    s_add_u32 s51, s50, 7168
    buffer_load_dwordx4 v7, s[36:39], s50 offen lds
    buffer_load_dwordx4 v7, s[36:39], s51 offen offset:1024 lds
    ds_read_b64_tr_b16 v[56:57], v40 offset:2048
    ds_read_b64_tr_b16 v[58:59], v40 offset:3072
    ds_read_b64_tr_b16 v[60:61], v41 offset:2048
    ds_read_b64_tr_b16 v[62:63], v41 offset:3072
    s_waitcnt vmcnt(10) lgkmcnt(4)
    v_mfma_f32_32x32x16_bf16 v[64:79], v[48:51], v[192:195], v[64:79]
    v_mfma_f32_32x32x16_bf16 v[80:95], v[52:55], v[192:195], v[80:95]
    v_mfma_f32_32x32x16_bf16 v[112:127], v[52:55], v[196:199], v[112:127]
    v_mfma_f32_32x32x16_bf16 v[96:111], v[48:51], v[196:199], v[96:111]
    s_add_u32 s80, s1, 11
    s_sub_u32 s52, s80, 12
    s_cmp_ge_u32 s80, 12
    s_cselect_b32 s80, s52, s80
    s_add_u32 s80, s80, s61
    s_lshl_b32 s50, s80, 10
    s_add_u32 s51, s50, s70
    buffer_load_dwordx4 v[216:219], v2, s[8:11], s51 offen sc1
    s_add_u32 s51, s50, s71
    buffer_load_dwordx4 v[220:223], v2, s[8:11], s51 offen sc1
    s_add_u32 s80, s2, 4
    s_and_b32 s80, s80, 7
    s_add_u32 m0, s76, 0
    s_lshl_b32 s50, s80, 14
    s_add_u32 s50, s50, s75
    s_add_u32 s51, s50, 7168
    buffer_load_dwordx4 v7, s[36:39], s50 offen lds
    buffer_load_dwordx4 v7, s[36:39], s51 offen offset:1024 lds
    ds_read_b64_tr_b16 v[48:49], v40 offset:4096
    ds_read_b64_tr_b16 v[50:51], v40 offset:5120
    ds_read_b64_tr_b16 v[52:53], v41 offset:4096
    ds_read_b64_tr_b16 v[54:55], v41 offset:5120
    s_waitcnt vmcnt(10) lgkmcnt(4)
    v_mfma_f32_32x32x16_bf16 v[64:79], v[56:59], v[200:203], v[64:79]
    v_mfma_f32_32x32x16_bf16 v[80:95], v[60:63], v[200:203], v[80:95]
    v_mfma_f32_32x32x16_bf16 v[112:127], v[60:63], v[204:207], v[112:127]
    v_mfma_f32_32x32x16_bf16 v[96:111], v[56:59], v[204:207], v[96:111]
    s_add_u32 s80, s2, 5
    s_and_b32 s80, s80, 7
    s_add_u32 m0, s76, 2048
    s_lshl_b32 s50, s80, 14
    s_add_u32 s50, s50, s75
    s_add_u32 s51, s50, 7168
    buffer_load_dwordx4 v7, s[36:39], s50 offen lds
    buffer_load_dwordx4 v7, s[36:39], s51 offen offset:1024 lds
    s_mov_b32 s53, 196608
    s_mov_b64 exec, 0xff
    buffer_load_dword v46, v42, s[8:11], s53 offen sc1
    s_mov_b64 exec, -1
    ds_read_b64_tr_b16 v[56:57], v40 offset:6144
    ds_read_b64_tr_b16 v[58:59], v40 offset:7168
    ds_read_b64_tr_b16 v[60:61], v41 offset:6144
    ds_read_b64_tr_b16 v[62:63], v41 offset:7168
    s_waitcnt vmcnt(9) lgkmcnt(4)
    v_mfma_f32_32x32x16_bf16 v[64:79], v[48:51], v[208:211], v[64:79]
    v_mfma_f32_32x32x16_bf16 v[80:95], v[52:55], v[208:211], v[80:95]
    v_mfma_f32_32x32x16_bf16 v[112:127], v[52:55], v[212:215], v[112:127]
    v_mfma_f32_32x32x16_bf16 v[96:111], v[48:51], v[212:215], v[96:111]
    s_add_u32 s80, s2, 6
    s_and_b32 s80, s80, 7
    s_add_u32 m0, s76, 4096
    s_lshl_b32 s50, s80, 14
    s_add_u32 s50, s50, s75
    s_add_u32 s51, s50, 7168
    buffer_load_dwordx4 v7, s[36:39], s50 offen lds
    buffer_load_dwordx4 v7, s[36:39], s51 offen offset:1024 lds
    ds_read_b64_tr_b16 v[48:49], v40 offset:8192
    ds_read_b64_tr_b16 v[50:51], v40 offset:9216
    ds_read_b64_tr_b16 v[52:53], v41 offset:8192
    ds_read_b64_tr_b16 v[54:55], v41 offset:9216
    s_waitcnt vmcnt(7) lgkmcnt(4)
    v_mfma_f32_32x32x16_bf16 v[64:79], v[56:59], v[216:219], v[64:79]
    v_mfma_f32_32x32x16_bf16 v[80:95], v[60:63], v[216:219], v[80:95]
    v_mfma_f32_32x32x16_bf16 v[112:127], v[60:63], v[220:223], v[112:127]
    v_mfma_f32_32x32x16_bf16 v[96:111], v[56:59], v[220:223], v[96:111]
    s_add_u32 s80, s2, 7
    s_and_b32 s80, s80, 7
    s_add_u32 m0, s76, 6144
    s_lshl_b32 s50, s80, 14
    s_add_u32 s50, s50, s75
    s_add_u32 s51, s50, 7168
    buffer_load_dwordx4 v7, s[36:39], s50 offen lds
    buffer_load_dwordx4 v7, s[36:39], s51 offen offset:1024 lds
    s_setprio 2
    s_mov_b32 s53, 196608
    s_waitcnt vmcnt(4)
    s_mov_b32 s56, 0
    s_mov_b64 exec, 0xff
    v_cmp_ne_u32 vcc, s48, v46
    s_cbranch_vccz L_pollx_76
L_poll_75:
    buffer_load_dword v46, v42, s[8:11], s53 offen sc1
    s_add_u32 s56, s56, 1
    s_waitcnt vmcnt(0)
    v_cmp_ne_u32 vcc, s48, v46
    s_cmp_gt_u32 s56, 200000
    s_cbranch_scc1 L_pollx_76
    s_cbranch_vccnz L_poll_75
L_pollx_76:
    s_mov_b64 exec, -1
    s_add_u32 s80, s2, 0
    s_and_b32 s80, s80, 7
    s_lshl_b32 s50, s80, 10
    s_add_u32 s51, s50, s72
    buffer_load_dwordx4 v[224:227], v2, s[8:11], s51 offen sc1
    s_add_u32 s51, s50, s73
    buffer_load_dwordx4 v[228:231], v2, s[8:11], s51 offen sc1
    s_add_u32 s80, s2, 1
    s_and_b32 s80, s80, 7
    s_lshl_b32 s50, s80, 10
    s_add_u32 s51, s50, s72
    buffer_load_dwordx4 v[232:235], v2, s[8:11], s51 offen sc1
    s_add_u32 s51, s50, s73
    buffer_load_dwordx4 v[236:239], v2, s[8:11], s51 offen sc1
    s_add_u32 s80, s2, 2
    s_and_b32 s80, s80, 7
    s_lshl_b32 s50, s80, 10
    s_add_u32 s51, s50, s72
    buffer_load_dwordx4 v[240:243], v2, s[8:11], s51 offen sc1
    s_add_u32 s51, s50, s73
    buffer_load_dwordx4 v[244:247], v2, s[8:11], s51 offen sc1
    s_add_u32 s80, s2, 3
    s_and_b32 s80, s80, 7
    s_lshl_b32 s50, s80, 10
    s_add_u32 s51, s50, s72
    buffer_load_dwordx4 v[248:251], v2, s[8:11], s51 offen sc1
    s_add_u32 s51, s50, s73
    buffer_load_dwordx4 v[252:255], v2, s[8:11], s51 offen sc1
    s_add_u32 s80, s2, 4
    s_and_b32 s80, s80, 7
    s_lshl_b32 s50, s80, 10
    s_add_u32 s51, s50, s72
    buffer_load_dwordx4 v[128:131], v2, s[8:11], s51 offen sc1
    s_add_u32 s51, s50, s73
    buffer_load_dwordx4 v[132:135], v2, s[8:11], s51 offen sc1
    s_add_u32 s80, s2, 5
    s_and_b32 s80, s80, 7
    s_lshl_b32 s50, s80, 10
    s_add_u32 s51, s50, s72
    buffer_load_dwordx4 v[136:139], v2, s[8:11], s51 offen sc1
    s_add_u32 s51, s50, s73
    buffer_load_dwordx4 v[140:143], v2, s[8:11], s51 offen sc1
    s_add_u32 s80, s2, 6
    s_and_b32 s80, s80, 7
    s_lshl_b32 s50, s80, 10
    s_add_u32 s51, s50, s72
    buffer_load_dwordx4 v[144:147], v2, s[8:11], s51 offen sc1
    s_add_u32 s51, s50, s73
    buffer_load_dwordx4 v[148:151], v2, s[8:11], s51 offen sc1
    s_add_u32 s80, s2, 7
    s_and_b32 s80, s80, 7
    s_lshl_b32 s50, s80, 10
    s_add_u32 s51, s50, s72
    buffer_load_dwordx4 v[152:155], v2, s[8:11], s51 offen sc1
    s_add_u32 s51, s50, s73
    buffer_load_dwordx4 v[156:159], v2, s[8:11], s51 offen sc1
    ds_read_b64_tr_b16 v[56:57], v40 offset:10240
    ds_read_b64_tr_b16 v[58:59], v40 offset:11264
    ds_read_b64_tr_b16 v[60:61], v41 offset:10240
    ds_read_b64_tr_b16 v[62:63], v41 offset:11264
    s_waitcnt vmcnt(14) lgkmcnt(4)
    v_mfma_f32_32x32x16_bf16 v[64:79], v[48:51], v[224:227], v[64:79]
    v_mfma_f32_32x32x16_bf16 v[80:95], v[52:55], v[224:227], v[80:95]
    v_mfma_f32_32x32x16_bf16 v[112:127], v[52:55], v[228:231], v[112:127]
    v_mfma_f32_32x32x16_bf16 v[96:111], v[48:51], v[228:231], v[96:111]
    ds_read_b64_tr_b16 v[48:49], v40 offset:12288
    ds_read_b64_tr_b16 v[50:51], v40 offset:13312
    ds_read_b64_tr_b16 v[52:53], v41 offset:12288
    ds_read_b64_tr_b16 v[54:55], v41 offset:13312
    s_waitcnt vmcnt(12) lgkmcnt(4)
    v_mfma_f32_32x32x16_bf16 v[64:79], v[56:59], v[232:235], v[64:79]
    v_mfma_f32_32x32x16_bf16 v[80:95], v[60:63], v[232:235], v[80:95]
    v_mfma_f32_32x32x16_bf16 v[112:127], v[60:63], v[236:239], v[112:127]
    v_mfma_f32_32x32x16_bf16 v[96:111], v[56:59], v[236:239], v[96:111]
    ds_read_b64_tr_b16 v[56:57], v40 offset:14336
    ds_read_b64_tr_b16 v[58:59], v40 offset:15360
    ds_read_b64_tr_b16 v[60:61], v41 offset:14336
    ds_read_b64_tr_b16 v[62:63], v41 offset:15360
    s_waitcnt vmcnt(10) lgkmcnt(4)
    v_mfma_f32_32x32x16_bf16 v[64:79], v[48:51], v[240:243], v[64:79]
    v_mfma_f32_32x32x16_bf16 v[80:95], v[52:55], v[240:243], v[80:95]
    v_mfma_f32_32x32x16_bf16 v[112:127], v[52:55], v[244:247], v[112:127]
    v_mfma_f32_32x32x16_bf16 v[96:111], v[48:51], v[244:247], v[96:111]
    ds_read_b64_tr_b16 v[48:49], v40 offset:0
    ds_read_b64_tr_b16 v[50:51], v40 offset:1024
    ds_read_b64_tr_b16 v[52:53], v41 offset:0
    ds_read_b64_tr_b16 v[54:55], v41 offset:1024
    s_waitcnt vmcnt(8) lgkmcnt(4)
    v_mfma_f32_32x32x16_bf16 v[64:79], v[56:59], v[248:251], v[64:79]
    v_mfma_f32_32x32x16_bf16 v[80:95], v[60:63], v[248:251], v[80:95]
    v_mfma_f32_32x32x16_bf16 v[112:127], v[60:63], v[252:255], v[112:127]
    v_mfma_f32_32x32x16_bf16 v[96:111], v[56:59], v[252:255], v[96:111]
    ds_read_b64_tr_b16 v[56:57], v40 offset:2048
    ds_read_b64_tr_b16 v[58:59], v40 offset:3072
    ds_read_b64_tr_b16 v[60:61], v41 offset:2048
    ds_read_b64_tr_b16 v[62:63], v41 offset:3072
    s_waitcnt vmcnt(6) lgkmcnt(4)
    v_mfma_f32_32x32x16_bf16 v[64:79], v[48:51], v[128:131], v[64:79]
    v_mfma_f32_32x32x16_bf16 v[80:95], v[52:55], v[128:131], v[80:95]
    v_mfma_f32_32x32x16_bf16 v[112:127], v[52:55], v[132:135], v[112:127]
    v_mfma_f32_32x32x16_bf16 v[96:111], v[48:51], v[132:135], v[96:111]
    ds_read_b64_tr_b16 v[48:49], v40 offset:4096
    ds_read_b64_tr_b16 v[50:51], v40 offset:5120
    ds_read_b64_tr_b16 v[52:53], v41 offset:4096
    ds_read_b64_tr_b16 v[54:55], v41 offset:5120
    s_waitcnt vmcnt(4) lgkmcnt(4)
    v_mfma_f32_32x32x16_bf16 v[64:79], v[56:59], v[136:139], v[64:79]
    v_mfma_f32_32x32x16_bf16 v[80:95], v[60:63], v[136:139], v[80:95]
    v_mfma_f32_32x32x16_bf16 v[112:127], v[60:63], v[140:143], v[112:127]
    v_mfma_f32_32x32x16_bf16 v[96:111], v[56:59], v[140:143], v[96:111]
    ds_read_b64_tr_b16 v[56:57], v40 offset:6144
    ds_read_b64_tr_b16 v[58:59], v40 offset:7168
    ds_read_b64_tr_b16 v[60:61], v41 offset:6144
    ds_read_b64_tr_b16 v[62:63], v41 offset:7168
    s_waitcnt vmcnt(2) lgkmcnt(4)
    v_mfma_f32_32x32x16_bf16 v[64:79], v[48:51], v[144:147], v[64:79]
    v_mfma_f32_32x32x16_bf16 v[80:95], v[52:55], v[144:147], v[80:95]
    v_mfma_f32_32x32x16_bf16 v[112:127], v[52:55], v[148:151], v[112:127]
    v_mfma_f32_32x32x16_bf16 v[96:111], v[48:51], v[148:151], v[96:111]
    s_waitcnt vmcnt(0) lgkmcnt(0)
    v_mfma_f32_32x32x16_bf16 v[80:95], v[60:63], v[152:155], v[80:95]
    v_mfma_f32_32x32x16_bf16 v[112:127], v[60:63], v[156:159], v[112:127]
    v_mfma_f32_32x32x16_bf16 v[96:111], v[56:59], v[156:159], v[96:111]
    v_mfma_f32_32x32x16_bf16 v[64:79], v[56:59], v[152:155], v[64:79]
    s_nop 7
    s_nop 0
    ds_write_b128 v16, v[80:83] offset:0
    ds_write_b128 v16, v[84:87] offset:1024
    ds_write_b128 v16, v[88:91] offset:2048
    ds_write_b128 v16, v[92:95] offset:3072
    ds_write_b128 v16, v[112:115] offset:8192
    ds_write_b128 v16, v[116:119] offset:9216
    ds_write_b128 v16, v[120:123] offset:10240
    ds_write_b128 v16, v[124:127] offset:11264
    ds_write_b128 v16, v[96:99] offset:4096
    ds_write_b128 v16, v[100:103] offset:5120
    ds_write_b128 v16, v[104:107] offset:6144
    ds_write_b128 v16, v[108:111] offset:7168
    s_waitcnt lgkmcnt(0)
    ds_write_b32 v14, v21
    s_mov_b32 s56, 0
L_spin_78:
    ds_read_b32 v15, v13
    s_add_u32 s56, s56, 1
    s_waitcnt lgkmcnt(0)
    v_cmp_gt_u32 vcc, 18, v15
    s_cmp_gt_u32 s56, 2000000
    s_cbranch_scc1 L_spinx_79
    s_cbranch_vccnz L_spin_78
L_spinx_79:
    ds_read_b128 v[80:83], v17 offset:0
    ds_read_b128 v[84:87], v17 offset:1024
    ds_read_b128 v[88:91], v17 offset:2048
    ds_read_b128 v[92:95], v17 offset:3072
    ds_read_b128 v[96:99], v18 offset:0
    ds_read_b128 v[100:103], v18 offset:1024
    ds_read_b128 v[104:107], v18 offset:2048
    ds_read_b128 v[108:111], v18 offset:3072
    ds_read_b128 v[112:115], v19 offset:0
    ds_read_b128 v[116:119], v19 offset:1024
    ds_read_b128 v[120:123], v19 offset:2048
    ds_read_b128 v[124:127], v19 offset:3072
    s_waitcnt lgkmcnt(8)
    v_pk_add_f32 v[64:65], v[64:65], v[80:81]
    v_pk_add_f32 v[66:67], v[66:67], v[82:83]
    v_pk_add_f32 v[68:69], v[68:69], v[84:85]
    v_pk_add_f32 v[70:71], v[70:71], v[86:87]
    v_pk_add_f32 v[72:73], v[72:73], v[88:89]
    v_pk_add_f32 v[74:75], v[74:75], v[90:91]
    v_pk_add_f32 v[76:77], v[76:77], v[92:93]
    v_pk_add_f32 v[78:79], v[78:79], v[94:95]
    s_waitcnt lgkmcnt(4)
    v_pk_add_f32 v[64:65], v[64:65], v[96:97]
    v_pk_add_f32 v[66:67], v[66:67], v[98:99]
    v_pk_add_f32 v[68:69], v[68:69], v[100:101]
    v_pk_add_f32 v[70:71], v[70:71], v[102:103]
    v_pk_add_f32 v[72:73], v[72:73], v[104:105]
    v_pk_add_f32 v[74:75], v[74:75], v[106:107]
    v_pk_add_f32 v[76:77], v[76:77], v[108:109]
    v_pk_add_f32 v[78:79], v[78:79], v[110:111]
    s_waitcnt lgkmcnt(0)
    v_pk_add_f32 v[64:65], v[64:65], v[112:113]
    v_pk_add_f32 v[66:67], v[66:67], v[114:115]
    v_pk_add_f32 v[68:69], v[68:69], v[116:117]
    v_pk_add_f32 v[70:71], v[70:71], v[118:119]
    v_pk_add_f32 v[72:73], v[72:73], v[120:121]
    v_pk_add_f32 v[74:75], v[74:75], v[122:123]
    v_pk_add_f32 v[76:77], v[76:77], v[124:125]
    v_pk_add_f32 v[78:79], v[78:79], v[126:127]
    v_cvt_pk_bf16_f32 v24, v64, v65
    v_cvt_pk_bf16_f32 v25, v66, v67
    v_cvt_pk_bf16_f32 v26, v68, v69
    v_cvt_pk_bf16_f32 v27, v70, v71
    v_cvt_pk_bf16_f32 v28, v72, v73
    v_cvt_pk_bf16_f32 v29, v74, v75
    v_cvt_pk_bf16_f32 v30, v76, v77
    v_cvt_pk_bf16_f32 v31, v78, v79
    s_nop 0
    v_permlane32_swap_b32 v24, v26
    v_permlane32_swap_b32 v25, v27
    v_permlane32_swap_b32 v28, v30
    v_permlane32_swap_b32 v29, v31
    buffer_store_dwordx4 v[24:27], v20, s[40:43], s77 offen
    buffer_store_dwordx4 v[28:31], v20, s[40:43], s77 offen offset:32
    s_endpgm
L_a_slow:
    v_mov_b32 v3, 1
    ds_write_b32 v17, v3 offset:128
    s_waitcnt vmcnt(0) lgkmcnt(0)
    v_mov_b32 v4, 0xff800000
    v_mov_b32 v5, 0xff800000
    v_mov_b32 v6, 0xff800000
    v_mov_b32 v7, 0xff800000
    v_mov_b32 v8, 0xff800000
    v_mov_b32 v9, 0xff800000
    v_mov_b32 v10, 0xff800000
    v_mov_b32 v11, 0xff800000
    s_mov_b32 s78, 3145728
    s_mov_b32 s56, 64
L_slow_max:
    buffer_load_dwordx4 v[28:31], v2, s[8:11], s78 offen sc1
    s_waitcnt vmcnt(0)
    v_mfma_f32_32x32x16_bf16 v[64:79], v[28:31], v[96:99], 0
    s_nop 7
    s_nop 3
    v_max3_f32 v4, v64, v65, v4
    v_max3_f32 v4, v66, v67, v4
    v_max3_f32 v4, v68, v69, v4
    v_max3_f32 v4, v70, v71, v4
    v_max3_f32 v4, v72, v73, v4
    v_max3_f32 v4, v74, v75, v4
    v_max3_f32 v4, v76, v77, v4
    v_max3_f32 v4, v78, v79, v4
    v_mfma_f32_32x32x16_bf16 v[64:79], v[28:31], v[100:103], 0
    s_nop 7
    s_nop 3
    v_max3_f32 v5, v64, v65, v5
    v_max3_f32 v5, v66, v67, v5
    v_max3_f32 v5, v68, v69, v5
    v_max3_f32 v5, v70, v71, v5
    v_max3_f32 v5, v72, v73, v5
    v_max3_f32 v5, v74, v75, v5
    v_max3_f32 v5, v76, v77, v5
    v_max3_f32 v5, v78, v79, v5
    v_mfma_f32_32x32x16_bf16 v[64:79], v[28:31], v[104:107], 0
    s_nop 7
    s_nop 3
    v_max3_f32 v6, v64, v65, v6
    v_max3_f32 v6, v66, v67, v6
    v_max3_f32 v6, v68, v69, v6
    v_max3_f32 v6, v70, v71, v6
    v_max3_f32 v6, v72, v73, v6
    v_max3_f32 v6, v74, v75, v6
    v_max3_f32 v6, v76, v77, v6
    v_max3_f32 v6, v78, v79, v6
    v_mfma_f32_32x32x16_bf16 v[64:79], v[28:31], v[108:111], 0
    s_nop 7
    s_nop 3
    v_max3_f32 v7, v64, v65, v7
    v_max3_f32 v7, v66, v67, v7
    v_max3_f32 v7, v68, v69, v7
    v_max3_f32 v7, v70, v71, v7
    v_max3_f32 v7, v72, v73, v7
    v_max3_f32 v7, v74, v75, v7
    v_max3_f32 v7, v76, v77, v7
    v_max3_f32 v7, v78, v79, v7
    v_mfma_f32_32x32x16_bf16 v[64:79], v[28:31], v[112:115], 0
    s_nop 7
    s_nop 3
    v_max3_f32 v8, v64, v65, v8
    v_max3_f32 v8, v66, v67, v8
    v_max3_f32 v8, v68, v69, v8
    v_max3_f32 v8, v70, v71, v8
    v_max3_f32 v8, v72, v73, v8
    v_max3_f32 v8, v74, v75, v8
    v_max3_f32 v8, v76, v77, v8
    v_max3_f32 v8, v78, v79, v8
    v_mfma_f32_32x32x16_bf16 v[64:79], v[28:31], v[116:119], 0
    s_nop 7
    s_nop 3
    v_max3_f32 v9, v64, v65, v9
    v_max3_f32 v9, v66, v67, v9
    v_max3_f32 v9, v68, v69, v9
    v_max3_f32 v9, v70, v71, v9
    v_max3_f32 v9, v72, v73, v9
    v_max3_f32 v9, v74, v75, v9
    v_max3_f32 v9, v76, v77, v9
    v_max3_f32 v9, v78, v79, v9
    v_mfma_f32_32x32x16_bf16 v[64:79], v[28:31], v[120:123], 0
    s_nop 7
    s_nop 3
    v_max3_f32 v10, v64, v65, v10
    v_max3_f32 v10, v66, v67, v10
    v_max3_f32 v10, v68, v69, v10
    v_max3_f32 v10, v70, v71, v10
    v_max3_f32 v10, v72, v73, v10
    v_max3_f32 v10, v74, v75, v10
    v_max3_f32 v10, v76, v77, v10
    v_max3_f32 v10, v78, v79, v10
    v_mfma_f32_32x32x16_bf16 v[64:79], v[28:31], v[124:127], 0
    s_nop 7
    s_nop 3
    v_max3_f32 v11, v64, v65, v11
    v_max3_f32 v11, v66, v67, v11
    v_max3_f32 v11, v68, v69, v11
    v_max3_f32 v11, v70, v71, v11
    v_max3_f32 v11, v72, v73, v11
    v_max3_f32 v11, v74, v75, v11
    v_max3_f32 v11, v76, v77, v11
    v_max3_f32 v11, v78, v79, v11
    s_add_u32 s78, s78, 1024
    s_sub_u32 s56, s56, 1
    s_cmp_lg_u32 s56, 0
    s_cbranch_scc1 L_slow_max
    v_mov_b32 v3, v4
    s_nop 1
    v_permlane32_swap_b32 v4, v3
    v_max_f32 v4, v4, v3
    v_mov_b32 v3, v5
    s_nop 1
    v_permlane32_swap_b32 v5, v3
    v_max_f32 v5, v5, v3
    v_mov_b32 v3, v6
    s_nop 1
    v_permlane32_swap_b32 v6, v3
    v_max_f32 v6, v6, v3
    v_mov_b32 v3, v7
    s_nop 1
    v_permlane32_swap_b32 v7, v3
    v_max_f32 v7, v7, v3
    v_mov_b32 v3, v8
    s_nop 1
    v_permlane32_swap_b32 v8, v3
    v_max_f32 v8, v8, v3
    v_mov_b32 v3, v9
    s_nop 1
    v_permlane32_swap_b32 v9, v3
    v_max_f32 v9, v9, v3
    v_mov_b32 v3, v10
    s_nop 1
    v_permlane32_swap_b32 v10, v3
    v_max_f32 v10, v10, v3
    v_mov_b32 v3, v11
    s_nop 1
    v_permlane32_swap_b32 v11, v3
    v_max_f32 v11, v11, v3
    s_mov_b32 s78, s100
    s_mov_b32 s56, 16
L_slow_pv:
    buffer_load_dwordx4 v[28:31], v2, s[8:11], s78 offen sc1
    s_mov_b64 exec, s[60:61]
    buffer_load_dwordx4 v[32:35], v26, s[8:11], s78 offen sc1
    buffer_load_dwordx4 v[36:39], v26, s[8:11], s78 offen offset:512 sc1
    s_mov_b64 exec, -1
    s_waitcnt vmcnt(0)
    v_mfma_f32_32x32x16_bf16 v[64:79], v[28:31], v[96:99], 0
    s_nop 7
    s_nop 3
    v_sub_f32 v64, v64, v4
    v_sub_f32 v65, v65, v4
    v_sub_f32 v66, v66, v4
    v_sub_f32 v67, v67, v4
    v_sub_f32 v68, v68, v4
    v_sub_f32 v69, v69, v4
    v_sub_f32 v70, v70, v4
    v_sub_f32 v71, v71, v4
    v_sub_f32 v72, v72, v4
    v_sub_f32 v73, v73, v4
    v_sub_f32 v74, v74, v4
    v_sub_f32 v75, v75, v4
    v_sub_f32 v76, v76, v4
    v_sub_f32 v77, v77, v4
    v_sub_f32 v78, v78, v4
    v_sub_f32 v79, v79, v4
    v_exp_f32 v64, v64
    v_exp_f32 v65, v65
    v_exp_f32 v66, v66
    v_exp_f32 v67, v67
    v_exp_f32 v68, v68
    v_exp_f32 v69, v69
    v_exp_f32 v70, v70
    v_exp_f32 v71, v71
    v_exp_f32 v72, v72
    v_exp_f32 v73, v73
    v_exp_f32 v74, v74
    v_exp_f32 v75, v75
    v_exp_f32 v76, v76
    v_exp_f32 v77, v77
    v_exp_f32 v78, v78
    v_exp_f32 v79, v79
    s_nop 1
    v_smfmac_f32_32x32x32_bf16 v[128:143], v[32:35], v[64:71], v27
    v_smfmac_f32_32x32x32_bf16 v[128:143], v[36:39], v[72:79], v27
    v_mfma_f32_32x32x16_bf16 v[64:79], v[28:31], v[100:103], 0
    s_nop 7
    s_nop 3
    v_sub_f32 v64, v64, v5
    v_sub_f32 v65, v65, v5
    v_sub_f32 v66, v66, v5
    v_sub_f32 v67, v67, v5
    v_sub_f32 v68, v68, v5
    v_sub_f32 v69, v69, v5
    v_sub_f32 v70, v70, v5
    v_sub_f32 v71, v71, v5
    v_sub_f32 v72, v72, v5
    v_sub_f32 v73, v73, v5
    v_sub_f32 v74, v74, v5
    v_sub_f32 v75, v75, v5
    v_sub_f32 v76, v76, v5
    v_sub_f32 v77, v77, v5
    v_sub_f32 v78, v78, v5
    v_sub_f32 v79, v79, v5
    v_exp_f32 v64, v64
    v_exp_f32 v65, v65
    v_exp_f32 v66, v66
    v_exp_f32 v67, v67
    v_exp_f32 v68, v68
    v_exp_f32 v69, v69
    v_exp_f32 v70, v70
    v_exp_f32 v71, v71
    v_exp_f32 v72, v72
    v_exp_f32 v73, v73
    v_exp_f32 v74, v74
    v_exp_f32 v75, v75
    v_exp_f32 v76, v76
    v_exp_f32 v77, v77
    v_exp_f32 v78, v78
    v_exp_f32 v79, v79
    s_nop 1
    v_smfmac_f32_32x32x32_bf16 v[144:159], v[32:35], v[64:71], v27
    v_smfmac_f32_32x32x32_bf16 v[144:159], v[36:39], v[72:79], v27
    v_mfma_f32_32x32x16_bf16 v[64:79], v[28:31], v[104:107], 0
    s_nop 7
    s_nop 3
    v_sub_f32 v64, v64, v6
    v_sub_f32 v65, v65, v6
    v_sub_f32 v66, v66, v6
    v_sub_f32 v67, v67, v6
    v_sub_f32 v68, v68, v6
    v_sub_f32 v69, v69, v6
    v_sub_f32 v70, v70, v6
    v_sub_f32 v71, v71, v6
    v_sub_f32 v72, v72, v6
    v_sub_f32 v73, v73, v6
    v_sub_f32 v74, v74, v6
    v_sub_f32 v75, v75, v6
    v_sub_f32 v76, v76, v6
    v_sub_f32 v77, v77, v6
    v_sub_f32 v78, v78, v6
    v_sub_f32 v79, v79, v6
    v_exp_f32 v64, v64
    v_exp_f32 v65, v65
    v_exp_f32 v66, v66
    v_exp_f32 v67, v67
    v_exp_f32 v68, v68
    v_exp_f32 v69, v69
    v_exp_f32 v70, v70
    v_exp_f32 v71, v71
    v_exp_f32 v72, v72
    v_exp_f32 v73, v73
    v_exp_f32 v74, v74
    v_exp_f32 v75, v75
    v_exp_f32 v76, v76
    v_exp_f32 v77, v77
    v_exp_f32 v78, v78
    v_exp_f32 v79, v79
    s_nop 1
    v_smfmac_f32_32x32x32_bf16 v[160:175], v[32:35], v[64:71], v27
    v_smfmac_f32_32x32x32_bf16 v[160:175], v[36:39], v[72:79], v27
    v_mfma_f32_32x32x16_bf16 v[64:79], v[28:31], v[108:111], 0
    s_nop 7
    s_nop 3
    v_sub_f32 v64, v64, v7
    v_sub_f32 v65, v65, v7
    v_sub_f32 v66, v66, v7
    v_sub_f32 v67, v67, v7
    v_sub_f32 v68, v68, v7
    v_sub_f32 v69, v69, v7
    v_sub_f32 v70, v70, v7
    v_sub_f32 v71, v71, v7
    v_sub_f32 v72, v72, v7
    v_sub_f32 v73, v73, v7
    v_sub_f32 v74, v74, v7
    v_sub_f32 v75, v75, v7
    v_sub_f32 v76, v76, v7
    v_sub_f32 v77, v77, v7
    v_sub_f32 v78, v78, v7
    v_sub_f32 v79, v79, v7
    v_exp_f32 v64, v64
    v_exp_f32 v65, v65
    v_exp_f32 v66, v66
    v_exp_f32 v67, v67
    v_exp_f32 v68, v68
    v_exp_f32 v69, v69
    v_exp_f32 v70, v70
    v_exp_f32 v71, v71
    v_exp_f32 v72, v72
    v_exp_f32 v73, v73
    v_exp_f32 v74, v74
    v_exp_f32 v75, v75
    v_exp_f32 v76, v76
    v_exp_f32 v77, v77
    v_exp_f32 v78, v78
    v_exp_f32 v79, v79
    s_nop 1
    v_smfmac_f32_32x32x32_bf16 v[176:191], v[32:35], v[64:71], v27
    v_smfmac_f32_32x32x32_bf16 v[176:191], v[36:39], v[72:79], v27
    v_mfma_f32_32x32x16_bf16 v[64:79], v[28:31], v[112:115], 0
    s_nop 7
    s_nop 3
    v_sub_f32 v64, v64, v8
    v_sub_f32 v65, v65, v8
    v_sub_f32 v66, v66, v8
    v_sub_f32 v67, v67, v8
    v_sub_f32 v68, v68, v8
    v_sub_f32 v69, v69, v8
    v_sub_f32 v70, v70, v8
    v_sub_f32 v71, v71, v8
    v_sub_f32 v72, v72, v8
    v_sub_f32 v73, v73, v8
    v_sub_f32 v74, v74, v8
    v_sub_f32 v75, v75, v8
    v_sub_f32 v76, v76, v8
    v_sub_f32 v77, v77, v8
    v_sub_f32 v78, v78, v8
    v_sub_f32 v79, v79, v8
    v_exp_f32 v64, v64
    v_exp_f32 v65, v65
    v_exp_f32 v66, v66
    v_exp_f32 v67, v67
    v_exp_f32 v68, v68
    v_exp_f32 v69, v69
    v_exp_f32 v70, v70
    v_exp_f32 v71, v71
    v_exp_f32 v72, v72
    v_exp_f32 v73, v73
    v_exp_f32 v74, v74
    v_exp_f32 v75, v75
    v_exp_f32 v76, v76
    v_exp_f32 v77, v77
    v_exp_f32 v78, v78
    v_exp_f32 v79, v79
    s_nop 1
    v_smfmac_f32_32x32x32_bf16 v[192:207], v[32:35], v[64:71], v27
    v_smfmac_f32_32x32x32_bf16 v[192:207], v[36:39], v[72:79], v27
    v_mfma_f32_32x32x16_bf16 v[64:79], v[28:31], v[116:119], 0
    s_nop 7
    s_nop 3
    v_sub_f32 v64, v64, v9
    v_sub_f32 v65, v65, v9
    v_sub_f32 v66, v66, v9
    v_sub_f32 v67, v67, v9
    v_sub_f32 v68, v68, v9
    v_sub_f32 v69, v69, v9
    v_sub_f32 v70, v70, v9
    v_sub_f32 v71, v71, v9
    v_sub_f32 v72, v72, v9
    v_sub_f32 v73, v73, v9
    v_sub_f32 v74, v74, v9
    v_sub_f32 v75, v75, v9
    v_sub_f32 v76, v76, v9
    v_sub_f32 v77, v77, v9
    v_sub_f32 v78, v78, v9
    v_sub_f32 v79, v79, v9
    v_exp_f32 v64, v64
    v_exp_f32 v65, v65
    v_exp_f32 v66, v66
    v_exp_f32 v67, v67
    v_exp_f32 v68, v68
    v_exp_f32 v69, v69
    v_exp_f32 v70, v70
    v_exp_f32 v71, v71
    v_exp_f32 v72, v72
    v_exp_f32 v73, v73
    v_exp_f32 v74, v74
    v_exp_f32 v75, v75
    v_exp_f32 v76, v76
    v_exp_f32 v77, v77
    v_exp_f32 v78, v78
    v_exp_f32 v79, v79
    s_nop 1
    v_smfmac_f32_32x32x32_bf16 v[208:223], v[32:35], v[64:71], v27
    v_smfmac_f32_32x32x32_bf16 v[208:223], v[36:39], v[72:79], v27
    v_mfma_f32_32x32x16_bf16 v[64:79], v[28:31], v[120:123], 0
    s_nop 7
    s_nop 3
    v_sub_f32 v64, v64, v10
    v_sub_f32 v65, v65, v10
    v_sub_f32 v66, v66, v10
    v_sub_f32 v67, v67, v10
    v_sub_f32 v68, v68, v10
    v_sub_f32 v69, v69, v10
    v_sub_f32 v70, v70, v10
    v_sub_f32 v71, v71, v10
    v_sub_f32 v72, v72, v10
    v_sub_f32 v73, v73, v10
    v_sub_f32 v74, v74, v10
    v_sub_f32 v75, v75, v10
    v_sub_f32 v76, v76, v10
    v_sub_f32 v77, v77, v10
    v_sub_f32 v78, v78, v10
    v_sub_f32 v79, v79, v10
    v_exp_f32 v64, v64
    v_exp_f32 v65, v65
    v_exp_f32 v66, v66
    v_exp_f32 v67, v67
    v_exp_f32 v68, v68
    v_exp_f32 v69, v69
    v_exp_f32 v70, v70
    v_exp_f32 v71, v71
    v_exp_f32 v72, v72
    v_exp_f32 v73, v73
    v_exp_f32 v74, v74
    v_exp_f32 v75, v75
    v_exp_f32 v76, v76
    v_exp_f32 v77, v77
    v_exp_f32 v78, v78
    v_exp_f32 v79, v79
    s_nop 1
    v_smfmac_f32_32x32x32_bf16 v[224:239], v[32:35], v[64:71], v27
    v_smfmac_f32_32x32x32_bf16 v[224:239], v[36:39], v[72:79], v27
    v_mfma_f32_32x32x16_bf16 v[64:79], v[28:31], v[124:127], 0
    s_nop 7
    s_nop 3
    v_sub_f32 v64, v64, v11
    v_sub_f32 v65, v65, v11
    v_sub_f32 v66, v66, v11
    v_sub_f32 v67, v67, v11
    v_sub_f32 v68, v68, v11
    v_sub_f32 v69, v69, v11
    v_sub_f32 v70, v70, v11
    v_sub_f32 v71, v71, v11
    v_sub_f32 v72, v72, v11
    v_sub_f32 v73, v73, v11
    v_sub_f32 v74, v74, v11
    v_sub_f32 v75, v75, v11
    v_sub_f32 v76, v76, v11
    v_sub_f32 v77, v77, v11
    v_sub_f32 v78, v78, v11
    v_sub_f32 v79, v79, v11
    v_exp_f32 v64, v64
    v_exp_f32 v65, v65
    v_exp_f32 v66, v66
    v_exp_f32 v67, v67
    v_exp_f32 v68, v68
    v_exp_f32 v69, v69
    v_exp_f32 v70, v70
    v_exp_f32 v71, v71
    v_exp_f32 v72, v72
    v_exp_f32 v73, v73
    v_exp_f32 v74, v74
    v_exp_f32 v75, v75
    v_exp_f32 v76, v76
    v_exp_f32 v77, v77
    v_exp_f32 v78, v78
    v_exp_f32 v79, v79
    s_nop 1
    v_smfmac_f32_32x32x32_bf16 v[240:255], v[32:35], v[64:71], v27
    v_smfmac_f32_32x32x32_bf16 v[240:255], v[36:39], v[72:79], v27
    s_add_u32 s78, s78, 1024
    s_sub_u32 s56, s56, 1
    s_cmp_lg_u32 s56, 0
    s_cbranch_scc1 L_slow_pv
    s_branch L_a_merge_full
L_end:
    s_endpgm
L_code_end:
.section .rodata,"a"
.p2align 6
.amdhsa_kernel parallel_sum__grouped_kv_mqa__glu_gated_swiglu__prompt_kernel
  .amdhsa_next_free_vgpr 256
  .amdhsa_next_free_sgpr 102
  .amdhsa_accum_offset 256
  .amdhsa_group_segment_fixed_size 0
  .amdhsa_kernarg_size 96
  .amdhsa_user_sgpr_count 2
  .amdhsa_user_sgpr_kernarg_segment_ptr 1
  .amdhsa_system_sgpr_workgroup_id_x 1
.end_amdhsa_kernel
```
